```python
import torch

def _softmax(x, axis=-1):
    return torch.softmax(x, dim=axis)
def _gelu(x):
    return torch.nn.functional.gelu(x, approximate="tanh")
def _silu(x):
    return torch.nn.functional.silu(x)
def _sigmoid(x):
    return torch.sigmoid(x)
def _layernorm(x, axis=-1, eps=1e-5):
    m = x.mean(dim=axis, keepdim=True)
    v = x.var(dim=axis, keepdim=True, unbiased=False)
    return (x - m) / torch.sqrt(v + eps)
def _scatter_add(tgt, idx, src, axis=0):
    return tgt.clone().index_add_(axis, idx, src)
def _segment_sum(src, seg, n):
    out = torch.zeros((n,) + src.shape[1:], dtype=src.dtype)
    return out.index_add_(0, seg, src)
def _pad(x, pw):
    flat = tuple(v for pair in reversed(pw) for v in pair)
    return torch.nn.functional.pad(x, flat)

kernel_name = 'standalone__window_attn_swin__vision'

def setup_inputs():

    _w = (lambda a: (lambda t: t.to(torch.bfloat16) if t.is_floating_point() else t)(torch.as_tensor(a)))
    H = W = 384
    C = 192
    ws = 8
    nh = 4
    shift = ws // 2
    coords = torch.stack(torch.meshgrid(torch.arange(ws), torch.arange(ws), indexing='ij'), 0).reshape(2, -1)
    rel = coords[:, :, None] - coords[:, None, :]
    rel[0] += ws - 1
    rel[1] += ws - 1
    rel[0] *= 2 * ws - 1
    rp_idx = rel.sum(0).to(torch.int64)
    img_mask = torch.zeros((1, H, W, 1), dtype=float)
    cnt = 0
    for hs in (slice(0, H - ws), slice(H - ws, H - shift), slice(H - shift, H)):
        for vs in (slice(0, W - ws), slice(W - ws, W - shift), slice(W - shift, W)):
            img_mask[:, hs, vs, :] = cnt
            cnt += 1
    mw = img_mask.reshape(1, H // ws, ws, W // ws, ws, 1).permute(0, 1, 3, 2, 4, 5).reshape(-1, ws * ws)
    am = mw[:, :, None] - mw[:, None, :]
    attn_mask = torch.where(am != 0, -100.0, 0.0).to(float)
    return {
        "x": _w((lambda *s: torch.randn(*s, dtype=torch.bfloat16) * 1.6)(1, H, W, C)),
        "wqkv": _w((lambda *s: torch.randn(*s, dtype=torch.bfloat16) * 1.6)(C, 3 * C) * 0.02),
        "wo": _w((lambda *s: torch.randn(*s, dtype=torch.bfloat16) * 0.05)(C, C) * 0.02),
        "rpb": _w((lambda *s: torch.randn(*s, dtype=torch.bfloat16) * 0.2)((2 * ws - 1) * (2 * ws - 1), nh)),
        "rp_idx": _w(rp_idx),
        "attn_mask": _w(attn_mask),
    }

def reference(x, wqkv, wo, rpb, rp_idx, attn_mask):
    B, H, W, C = x.shape
    N = rp_idx.shape[0]
    ws = int(round(N ** 0.5))
    nh = rpb.shape[-1]
    hd = C // nh
    shift = ws // 2
    xs = torch.roll(x, (-shift, -shift), (1, 2))
    nWh = H // ws
    nWw = W // ws
    xw = (lambda x, *d: x.permute(*d))(xs.reshape(B, nWh, ws, nWw, ws, C), 0, 1, 3, 2, 4, 5).reshape(B * nWh * nWw, N, C)
    qkv = (lambda x, *d: x.permute(*d))(torch.einsum('wnc,cd->wnd', xw, wqkv).reshape(-1, N, 3, nh, hd), 2, 0, 3, 1, 4)
    q, k, v = qkv[0], qkv[1], qkv[2]
    attn = torch.einsum('whid,whjd->whij', q, k) * (hd ** -0.5)
    bias = (lambda x, *d: x.permute(*d))(rpb[rp_idx.reshape(-1)].reshape(N, N, nh), 2, 0, 1)
    attn = attn + bias[None, :, :, :]
    attn = (attn.reshape(B, nWh * nWw, nh, N, N) + attn_mask[None, :, None, :, :]).reshape(-1, nh, N, N)
    attn = _softmax(attn, axis=-1)
    out = (lambda x, *d: x.permute(*d))(torch.einsum('whij,whjd->whid', attn, v), 0, 2, 1, 3).reshape(-1, N, C)
    out = torch.einsum('wnc,cd->wnd', out, wo)
    out = (lambda x, *d: x.permute(*d))(out.reshape(B, nWh, nWw, ws, ws, C), 0, 1, 3, 2, 4, 5).reshape(B, H, W, C)
    return torch.roll(out, (shift, shift), (1, 2))
```

```asm
; @launch grid=(256,1,1) block=(256,1,1) lds=163840
.amdgcn_target "amdgcn-amd-amdhsa--gfx950"
.text
.globl standalone__window_attn_swin__vision_kernel
.p2align 8
.type standalone__window_attn_swin__vision_kernel,@function
standalone__window_attn_swin__vision_kernel:
    s_cmp_ge_u32 s2, 256
    s_cbranch_scc1 DONE
    s_load_dwordx4 s[52:55], s[0:1], 0
    s_load_dwordx4 s[56:59], s[0:1], 16
    s_load_dwordx2 s[60:61], s[0:1], 48
    v_and_b32 v40, 63, v0
    v_lshrrev_b32 v41, 6, v0
    s_nop 0
    v_readfirstlane_b32 s28, v41
    v_and_b32 v41, 15, v40
    v_min_u32 v41, 8, v41
    v_lshlrev_b32 v42, 8, v41
    v_add_u32 v42, s2, v42
    v_mul_u32_u24 v43, 43691, v42
    v_lshrrev_b32 v43, 21, v43
    v_mul_u32_u24 v44, 48, v43
    v_sub_u32 v42, v42, v44
    v_mul_u32_u24 v44, 3072, v42
    v_add_u32 v44, 1536, v44
    v_cmp_ne_u32 vcc, 47, v42
    s_nop 1
    v_cndmask_b32 v44, 0, v44, vcc
    v_cndmask_b32 v45, 1, 0, vcc
    v_mul_u32_u24 v46, 1179648, v43
    v_add_u32 v44, v44, v46
    v_add_u32 v244, 589824, v44
    v_add_u32 v44, 1179648, v44
    v_subrev_u32 v46, 56623104, v44
    v_cmp_eq_u32 vcc, 47, v43
    s_nop 1
    v_cndmask_b32 v44, v44, v46, vcc
    v_cmp_lt_u32 vcc, 15, v40
    s_nop 1
    v_cndmask_b32 v244, v244, v44, vcc
    v_cmp_eq_u32 vcc, 15, v42
    s_nop 1
    v_cndmask_b32 v44, 0, 1, vcc
    v_min_u32 v44, v44, v41
    v_sub_u32 v44, v45, v44
    v_cmp_lt_u32 vcc, 31, v40
    s_nop 1
    v_cndmask_b32 v244, v244, v44, vcc
    v_sub_u32 v45, 0, v45
    v_and_b32 v45, 0xc31044fe, v45
    v_cmp_lt_u32 vcc, 47, v40
    s_nop 1
    v_cndmask_b32 v244, v244, v45, vcc
    s_lshr_b32 s46, s28, 1
    s_xor_b32 s46, s46, s28
    s_and_b32 s46, s46, 1
    s_lshl_b32 s46, s46, 2
    s_mul_i32 s47, s28, 147456
    s_mul_i32 s31, s28, 3072
    v_lshrrev_b32 v41, 4, v40
    v_or_b32 v41, s46, v41
    v_and_b32 v42, 7, v40
    v_xor_b32 v41, v41, v42
    v_lshlrev_b32 v41, 4, v41
    v_lshrrev_b32 v42, 3, v40
    v_mul_u32_u24 v42, 384, v42
    v_add3_u32 v242, v41, v42, s47
    v_mov_b32 v41, 145920
    v_mov_b32 v42, -1536
    v_cmp_gt_u32 vcc, 32, v40
    s_nop 1
    v_cndmask_b32 v243, v42, v41, vcc
    s_mul_i32 s46, s28, 9216
    s_add_u32 s34, s46, 49152
    v_lshlrev_b32 v47, 4, v40
    v_add_u32 v50, s46, v47
    s_and_b32 s46, s28, 1
    s_lshl_b32 s46, s46, 5
    v_xor_b32 v191, s46, v50
    v_xor_b32 v192, 64, v191
    v_cmp_lt_u32 vcc, 15, v40
    s_nop 1
    v_cndmask_b32 v193, v191, v192, vcc
    v_cmp_gt_u32 vcc, 32, v40
    s_nop 1
    v_cndmask_b32 v194, v191, v192, vcc
    v_cmp_lt_u32 vcc, 47, v40
    s_nop 1
    v_cndmask_b32 v195, v191, v192, vcc
    v_lshrrev_b32 v43, 4, v40
    v_and_b32 v44, 15, v40
    s_lshl_b32 s46, s28, 1
    v_mul_u32_u24 v51, 120, v43
    v_lshl_add_u32 v51, v44, 3, v51
    v_add_u32 v51, s46, v51
    v_mul_u32_u24 v64, 80, v43
    v_lshl_add_u32 v64, v44, 2, v64
    s_lshr_b32 s46, s2, 3
    s_lshl_b32 s46, s46, 2
    s_add_u32 s46, s46, s28
    s_lshl_b32 s46, s46, 10
    v_add_u32 v48, s46, v47
    s_mov_b32 s35, 131072
    s_cmp_ge_u32 s2, 208
    s_cselect_b32 s41, 0xc31044fe, 0
    s_mov_b32 s30, 0
    s_waitcnt lgkmcnt(0)
    s_mov_b32 s24, s58
    s_mov_b32 s25, s59
    s_mov_b32 s26, 1800
    s_mov_b32 s27, 0x00020000
    buffer_load_ushort v52, v51, s[24:27], 0 offen offset:0
    buffer_load_ushort v53, v51, s[24:27], 0 offen offset:480
    buffer_load_ushort v54, v51, s[24:27], 0 offen offset:960
    buffer_load_ushort v55, v51, s[24:27], 0 offen offset:1440
    s_mov_b32 s16, s54
    s_mov_b32 s17, s55
    s_mov_b32 s18, 221184
    s_mov_b32 s19, 0x00020000
    buffer_load_dwordx4 v[176:179], v48, s[16:19], 0 offen
    buffer_load_dwordx4 v[180:183], v48, s[16:19], s35 offen
    s_mov_b32 s20, s56
    s_mov_b32 s21, s57
    s_mov_b32 s22, 73728
    s_mov_b32 s23, 0x00020000
    buffer_load_dwordx4 v[184:187], v48, s[20:23], 0 offen
    s_mov_b32 s4, s52
    s_mov_b32 s5, s53
    s_mov_b32 s6, 56623104
    s_mov_b32 s7, 0x00020000
    v_readlane_b32 s36, v244, 0
    v_readlane_b32 s37, v244, 16
    v_readlane_b32 s38, v244, 32
    s_nop 1
    v_mad_i32_i24 v242, v243, s38, v242
    s_add_u32 m0, s31, 0
    s_nop 0
    buffer_load_dwordx4 v242, s[4:7], s36 offen offset:0 lds
    s_add_u32 m0, s31, 12288
    s_nop 0
    buffer_load_dwordx4 v242, s[4:7], s37 offen offset:0 lds
    s_mov_b32 s8, s52
    s_mov_b32 s9, s53
    s_mov_b32 s10, 56623104
    s_mov_b32 s11, 0x00020000
    s_mov_b32 s12, s60
    s_mov_b32 s13, s61
    s_mov_b32 s14, 56623104
    s_mov_b32 s15, 0x00020000
    s_mov_b32 s35, 0
    s_add_u32 m0, s34, 0
    s_nop 0
    buffer_load_dwordx4 v191, s[16:19], s35 offen offset:0 lds
    s_mul_i32 s46, s28, 96
    v_add_u32 v43, 0, v40
    v_mul_u32_u24 v44, 10923, v43
    v_lshrrev_b32 v44, 16, v44
    v_mul_u32_u24 v45, 6, v44
    v_sub_u32 v43, v43, v45
    v_lshl_add_u32 v43, v43, 4, s46
    v_lshrrev_b32 v45, 3, v44
    v_mul_u32_u24 v45, 147456, v45
    v_and_b32 v44, 7, v44
    v_mul_u32_u24 v46, 384, v44
    v_add3_u32 v249, v43, v45, v46
    v_cmp_gt_u32 vcc, 4, v44
    s_nop 1
    v_cndmask_b32 v252, v42, v41, vcc
    buffer_load_dwordx4 v191, s[16:19], s35 offen offset:1024 lds
    v_add_u32 v43, 64, v40
    v_mul_u32_u24 v44, 10923, v43
    v_lshrrev_b32 v44, 16, v44
    v_mul_u32_u24 v45, 6, v44
    v_sub_u32 v43, v43, v45
    v_lshl_add_u32 v43, v43, 4, s46
    v_lshrrev_b32 v45, 3, v44
    v_mul_u32_u24 v45, 147456, v45
    v_and_b32 v44, 7, v44
    v_mul_u32_u24 v46, 384, v44
    v_add3_u32 v250, v43, v45, v46
    v_cmp_gt_u32 vcc, 4, v44
    s_nop 1
    v_cndmask_b32 v253, v42, v41, vcc
    v_add_u32 v43, 128, v40
    buffer_load_dwordx4 v193, s[16:19], s35 offen offset:2048 lds
    v_mul_u32_u24 v44, 10923, v43
    v_lshrrev_b32 v44, 16, v44
    v_mul_u32_u24 v45, 6, v44
    v_sub_u32 v43, v43, v45
    v_lshl_add_u32 v43, v43, 4, s46
    v_lshrrev_b32 v45, 3, v44
    v_mul_u32_u24 v45, 147456, v45
    v_and_b32 v44, 7, v44
    v_mul_u32_u24 v46, 384, v44
    v_add3_u32 v251, v43, v45, v46
    v_cmp_gt_u32 vcc, 4, v44
    s_nop 1
    v_cndmask_b32 v254, v42, v41, vcc
    v_lshrrev_b32 v56, 4, v40
    v_bfe_u32 v58, v40, 2, 2
    buffer_load_dwordx4 v192, s[16:19], s35 offen offset:3072 lds
    v_and_b32 v59, 3, v40
    v_lshrrev_b32 v60, 5, v40
    v_bfe_u32 v61, v40, 4, 1
    v_and_b32 v62, 7, v40
    v_bfe_u32 v63, v40, 3, 2
    v_mul_u32_u24 v41, 40, v63
    v_lshlrev_b32 v42, 2, v60
    v_sub_u32 v41, v41, v42
    v_add3_u32 v41, v41, v62, 4
    s_lshl_b32 s47, s28, 11
    s_add_u32 s47, s47, 24576
    v_lshl_add_u32 v49, v41, 2, s47
    v_add_u32 v64, s47, v64
    v_and_b32 v44, 2, v58
    s_mov_b32 s35, 4096
    s_add_u32 m0, s34, 4096
    s_nop 0
    buffer_load_dwordx4 v194, s[16:19], s35 offen offset:0 lds
    v_lshl_add_u32 v46, v59, 3, 0
    v_add_u32 v46, 49152, v46
    v_or_b32 v45, v44, v60
    v_lshlrev_b32 v45, 5, v45
    v_lshl_add_u32 v41, v60, 3, v58
    v_mul_u32_u24 v41, 1152, v41
    v_add_u32 v41, v41, v46
    v_mul_u32_u24 v42, 32, v61
    v_add_u32 v42, 0, v42
    v_add_u32 v42, s46, v42
    v_xor_b32 v42, v42, v45
    v_add_u32 v246, v41, v42
    v_mul_u32_u24 v42, 320, v61
    v_add_u32 v42, 64, v42
    buffer_load_dwordx4 v191, s[16:19], s35 offen offset:1024 lds
    v_add_u32 v42, s46, v42
    v_xor_b32 v42, v42, v45
    v_add_u32 v245, v41, v42
    v_mul_u32_u24 v42, 32, v61
    v_add_u32 v42, 416, v42
    v_add_u32 v42, s46, v42
    v_xor_b32 v42, v42, v45
    v_add_u32 v3, v41, v42
    v_or_b32 v45, v44, v61
    v_lshlrev_b32 v45, 5, v45
    v_lshl_add_u32 v41, v56, 3, v58
    v_mul_u32_u24 v41, 1152, v41
    v_add_u32 v41, v41, v46
    s_add_u32 s47, s46, 768
    buffer_load_dwordx4 v195, s[16:19], s35 offen offset:2048 lds
    v_xor_b32 v42, s47, v45
    v_add_u32 v188, v41, v42
    s_add_u32 s47, s46, 800
    v_xor_b32 v42, s47, v45
    v_add_u32 v189, v41, v42
    s_add_u32 s47, s46, 832
    v_xor_b32 v42, s47, v45
    v_add_u32 v190, v41, v42
    v_lshl_add_u32 v41, v56, 2, v58
    v_mul_u32_u24 v41, 384, v41
    s_add_u32 s47, s46, 64
    v_xor_b32 v42, s47, v45
    v_add3_u32 v42, v41, v42, v46
    v_accvgpr_write_b32 a253, v42
    buffer_load_dwordx4 v192, s[16:19], s35 offen offset:3072 lds
    v_lshl_add_u32 v42, v59, 4, s46
    v_xor_b32 v42, v42, v45
    v_add_u32 v41, 49152, v41
    v_add_u32 v42, v41, v42
    v_accvgpr_write_b32 a252, v42
    v_add_u32 v41, 0, v40
    v_mul_u32_u24 v41, 43691, v41
    v_lshrrev_b32 v41, 20, v41
    v_and_b32 v42, 2, v41
    v_bfe_u32 v41, v41, 2, 1
    v_or_b32 v41, v41, v42
    v_lshlrev_b32 v41, 5, v41
    v_xor_b32 v255, v41, v50
    v_add_u32 v41, 64, v40
    s_mov_b32 s35, 8192
    s_add_u32 m0, s34, 8192
    s_nop 0
    buffer_load_dwordx4 v192, s[16:19], s35 offen offset:0 lds
    v_mul_u32_u24 v41, 43691, v41
    v_lshrrev_b32 v41, 20, v41
    v_and_b32 v42, 2, v41
    v_bfe_u32 v41, v41, 2, 1
    v_or_b32 v41, v41, v42
    v_lshlrev_b32 v41, 5, v41
    v_xor_b32 v2, v41, v50
    v_add_u32 v41, 128, v40
    v_mul_u32_u24 v41, 43691, v41
    v_lshrrev_b32 v41, 20, v41
    v_and_b32 v42, 2, v41
    v_bfe_u32 v41, v41, 2, 1
    v_or_b32 v41, v41, v42
    v_lshlrev_b32 v41, 5, v41
    s_add_u32 m0, s31, 896
    s_nop 0
    buffer_load_dwordx4 v242, s[4:7], s36 offen offset:128 lds
    v_xor_b32 v0, v41, v50
    v_lshrrev_b32 v41, 1, v62
    v_and_b32 v42, 1, v63
    v_lshl_or_b32 v41, v42, 2, v41
    v_xor_b32 v41, v41, v60
    v_mul_u32_u24 v42, 6144, v63
    v_lshl_add_u32 v42, v62, 7, v42
    v_xor_b32 v43, 0, v41
    v_lshl_add_u32 v232, v43, 4, v42
    v_xor_b32 v43, 2, v41
    v_lshl_add_u32 v233, v43, 4, v42
    v_xor_b32 v43, 4, v41
    v_lshl_add_u32 v234, v43, 4, v42
    v_xor_b32 v43, 6, v41
    s_add_u32 m0, s31, 1792
    s_nop 0
    buffer_load_dwordx4 v242, s[4:7], s36 offen offset:256 lds
    v_lshl_add_u32 v235, v43, 4, v42
    v_bfe_u32 v44, v40, 2, 1
    v_bfe_u32 v45, v40, 3, 1
    v_lshl_add_u32 v46, v45, 2, v59
    v_lshrrev_b32 v41, 1, v46
    v_lshl_or_b32 v41, v44, 2, v41
    v_xor_b32 v41, v41, v56
    v_mul_u32_u24 v42, 3072, v44
    v_lshl_add_u32 v42, v46, 7, v42
    v_xor_b32 v43, 0, v41
    v_lshl_add_u32 v236, v43, 4, v42
    v_xor_b32 v43, 4, v41
    v_lshl_add_u32 v237, v43, 4, v42
    v_lshlrev_b32 v41, 4, v40
    s_add_u32 m0, s31, 13184
    s_nop 0
    buffer_load_dwordx4 v242, s[4:7], s37 offen offset:128 lds
    v_add_u32 v238, 49152, v41
    s_lshl_b32 s47, s28, 10
    v_add_u32 v239, s47, v238
    s_lshl_b32 s47, s28, 13
    s_add_u32 s47, s47, 98304
    v_add_u32 v241, s47, v41
    s_add_u32 s51, s47, 6144
    v_lshl_add_u32 v41, v45, 4, v62
    v_mul_u32_u24 v41, 96, v41
    v_add_u32 v41, s47, v41
    v_lshl_add_u32 v247, v56, 4, v41
    v_lshl_add_u32 v248, v56, 3, v41
    v_add_u32 v248, 64, v248
    s_lshr_b32 s47, s28, 1
    s_add_u32 m0, s31, 14080
    s_nop 0
    buffer_load_dwordx4 v242, s[4:7], s37 offen offset:256 lds
    s_lshl_b32 s47, s47, 10
    s_and_b32 s29, s28, 1
    s_lshl_b32 s29, s29, 3
    s_add_u32 s47, s47, s29
    s_add_u32 s47, s47, 4096
    v_add_u32 v240, s47, v238
    s_mov_b32 s29, 0x3e553b95
    s_mov_b32 s42, 0xf0f0f0f0
    s_mov_b32 s43, 0x0f0f0f0f
    s_mov_b32 s44, 0xffff0000
    s_mov_b32 s45, 0xffff0000
    s_waitcnt vmcnt(18)
    v_lshlrev_b32 v52, 16, v52
    v_mul_f32 v52, 0x40ddb3d7, v52
    ds_write_b32 v64, v52 offset:0
    v_lshlrev_b32 v53, 16, v53
    v_mul_f32 v53, 0x40ddb3d7, v53
    ds_write_b32 v64, v53 offset:320
    v_lshlrev_b32 v54, 16, v54
    v_mul_f32 v54, 0x40ddb3d7, v54
    ds_write_b32 v64, v54 offset:640
    v_lshlrev_b32 v55, 16, v55
    v_mul_f32 v55, 0x40ddb3d7, v55
    ds_write_b32 v64, v55 offset:960
    ds_read2_b32 v[4:5], v49 offset0:143 offset1:142
    ds_read2_b32 v[6:7], v49 offset0:141 offset1:140
    ds_read2_b32 v[8:9], v49 offset0:103 offset1:102
    ds_read2_b32 v[10:11], v49 offset0:101 offset1:100
    ds_read2_b32 v[12:13], v49 offset0:63 offset1:62
    ds_read2_b32 v[14:15], v49 offset0:61 offset1:60
    ds_read2_b32 v[16:17], v49 offset0:23 offset1:22
    ds_read2_b32 v[18:19], v49 offset0:21 offset1:20
    ds_read2_b32 v[20:21], v49 offset0:163 offset1:162
    ds_read2_b32 v[22:23], v49 offset0:161 offset1:160
    ds_read2_b32 v[24:25], v49 offset0:123 offset1:122
    ds_read2_b32 v[26:27], v49 offset0:121 offset1:120
    ds_read2_b32 v[28:29], v49 offset0:83 offset1:82
    ds_read2_b32 v[30:31], v49 offset0:81 offset1:80
    ds_read2_b32 v[32:33], v49 offset0:43 offset1:42
    ds_read2_b32 v[34:35], v49 offset0:41 offset1:40
    ds_read2_b32 v[36:37], v49 offset0:3 offset1:2
    ds_read2_b32 v[38:39], v49 offset0:1 offset1:0
    s_waitcnt vmcnt(4) lgkmcnt(0)
    s_barrier
    ds_read_b64_tr_b16 a[0:1], v246 offset:0
    ds_read_b64_tr_b16 a[2:3], v246 offset:4608
    ds_read_b128 v[200:203], v232 offset:0
    ds_read_b64_tr_b16 a[4:5], v245 offset:0
    ds_read_b64_tr_b16 a[6:7], v245 offset:4608
    s_mov_b32 s35, 36864
    s_add_u32 m0, s34, 36864
    ds_read_b64_tr_b16 a[8:9], v3 offset:0
    buffer_load_dwordx4 v191, s[16:19], s35 offen offset:0 lds
    ds_read_b64_tr_b16 a[10:11], v3 offset:4608
    s_mov_b32 s35, 36864
    s_add_u32 m0, s34, 36864
    ds_read_b128 v[204:207], v234 offset:3072
    ds_read_b64_tr_b16 a[12:13], v246 offset:18432
    ds_read_b64_tr_b16 a[14:15], v246 offset:23040
    ds_read_b128 v[208:211], v233 offset:0
    ds_read_b64_tr_b16 a[16:17], v245 offset:18432
    ds_read_b64_tr_b16 a[18:19], v245 offset:23040
    ds_read_b64_tr_b16 a[20:21], v3 offset:18432
    ds_read_b64_tr_b16 a[22:23], v3 offset:23040
    ds_read_b64_tr_b16 a[144:145], v188 offset:0
    ds_read_b64_tr_b16 a[146:147], v188 offset:4608
    ds_read_b64_tr_b16 a[148:149], v189 offset:0
    ds_read_b64_tr_b16 a[150:151], v189 offset:4608
    ds_read_b64_tr_b16 a[152:153], v190 offset:0
    ds_read_b64_tr_b16 a[154:155], v190 offset:4608
    ds_read_b128 v[212:215], v235 offset:3072
    ds_read_b128 v[216:219], v236 offset:0
    ds_read_b128 v[220:223], v237 offset:6144
    s_waitcnt lgkmcnt(15)
    v_mfma_f32_32x32x16_bf16 v[104:119], a[0:3], v[200:203], 0
    buffer_load_dwordx4 v191, s[16:19], s35 offen offset:1024 lds
    s_mov_b32 s35, 36864
    s_add_u32 m0, s34, 36864
    v_mfma_f32_32x32x16_bf16 v[120:135], a[4:7], v[200:203], 0
    v_add_u32 v246, 36864, v246
    v_add_u32 v245, 36864, v245
    buffer_load_dwordx4 v193, s[16:19], s35 offen offset:2048 lds
    s_mov_b32 s35, 36864
    s_add_u32 m0, s34, 36864
    v_mfma_f32_32x32x16_bf16 v[136:151], a[8:11], v[200:203], 0
    ds_read_b128 v[200:203], v236 offset:12288
    v_add_u32 v3, 36864, v3
    buffer_load_dwordx4 v192, s[16:19], s35 offen offset:3072 lds
    s_mov_b32 s35, 40960
    s_add_u32 m0, s34, 40960
    v_mfma_f32_32x32x16_bf16 v[40:55], a[0:3], v[204:207], 0
    v_add_u32 v188, 36864, v188
    v_add_u32 v189, 36864, v189
    buffer_load_dwordx4 v194, s[16:19], s35 offen offset:0 lds
    s_mov_b32 s35, 40960
    s_add_u32 m0, s34, 40960
    v_mfma_f32_32x32x16_bf16 v[56:71], a[4:7], v[204:207], 0
    v_add_u32 v190, 36864, v190
    v_readlane_b32 s38, v244, 33
    buffer_load_dwordx4 v191, s[16:19], s35 offen offset:1024 lds
    s_mov_b32 s35, 40960
    s_add_u32 m0, s34, 40960
    v_mfma_f32_32x32x16_bf16 v[72:87], a[8:11], v[204:207], 0
    ds_read_b128 v[204:207], v237 offset:18432
    v_readlane_b32 s36, v244, 1
    buffer_load_dwordx4 v195, s[16:19], s35 offen offset:2048 lds
    s_mov_b32 s35, 40960
    s_add_u32 m0, s34, 40960
    s_waitcnt lgkmcnt(2)
    v_mfma_f32_32x32x16_bf16 v[104:119], a[12:15], v[208:211], v[104:119]
    v_mad_i32_i24 v242, v243, s38, v242
    buffer_load_dwordx4 v192, s[16:19], s35 offen offset:3072 lds
    s_mov_b32 s35, 45056
    s_add_u32 m0, s34, 45056
    v_mfma_f32_32x32x16_bf16 v[120:135], a[16:19], v[208:211], v[120:135]
    v_readlane_b32 s37, v244, 17
    v_readlane_b32 s38, v244, 34
    buffer_load_dwordx4 v192, s[16:19], s35 offen offset:0 lds
    s_mov_b32 s35, 73728
    s_add_u32 m0, s34, 73728
    v_mfma_f32_32x32x16_bf16 v[136:151], a[20:23], v[208:211], v[136:151]
    ds_read_b128 v[208:211], v234 offset:0
    v_readlane_b32 s40, v244, 48
    buffer_load_dwordx4 v191, s[16:19], s35 offen offset:0 lds
    v_mfma_f32_32x32x16_bf16 v[40:55], a[12:15], v[212:215], v[40:55]
    v_readlane_b32 s39, v244, 32
    v_readlane_b32 s32, v244, 0
    v_readlane_b32 s33, v244, 16
    v_mad_i32_i24 v249, v252, s39, v249
    buffer_load_dwordx4 v191, s[16:19], s35 offen offset:1024 lds
    v_mfma_f32_32x32x16_bf16 v[56:71], a[16:19], v[212:215], v[56:71]
    v_mad_i32_i24 v250, v253, s39, v250
    v_mad_i32_i24 v251, v254, s39, v251
    v_mfma_f32_32x32x16_bf16 v[72:87], a[20:23], v[212:215], v[72:87]
    buffer_load_dwordx4 v193, s[16:19], s35 offen offset:2048 lds
    ds_read_b128 v[212:215], v232 offset:3072
    v_mfma_f32_16x16x32_bf16 v[152:155], v[216:219], a[144:147], 0
    v_mfma_f32_16x16x32_bf16 v[156:159], v[216:219], a[148:151], 0
    buffer_load_dwordx4 v192, s[16:19], s35 offen offset:3072 lds
    s_mov_b32 s35, 77824
    s_add_u32 m0, s34, 77824
    v_mfma_f32_16x16x32_bf16 v[160:163], v[216:219], a[152:155], 0
    ds_read_b128 v[216:219], v235 offset:0
    v_mfma_f32_16x16x32_bf16 v[164:167], v[220:223], a[144:147], 0
    buffer_load_dwordx4 v194, s[16:19], s35 offen offset:0 lds
    v_mfma_f32_16x16x32_bf16 v[168:171], v[220:223], a[148:151], 0
    v_mfma_f32_16x16x32_bf16 v[172:175], v[220:223], a[152:155], 0
    buffer_load_dwordx4 v191, s[16:19], s35 offen offset:1024 lds
    s_waitcnt lgkmcnt(2)
    v_mfma_f32_16x16x32_bf16 v[88:91], v[200:203], a[144:147], 0
    ds_read_b128 v[220:223], v233 offset:3072
    v_mfma_f32_16x16x32_bf16 v[92:95], v[200:203], a[148:151], 0
    buffer_load_dwordx4 v195, s[16:19], s35 offen offset:2048 lds
    v_mfma_f32_16x16x32_bf16 v[96:99], v[200:203], a[152:155], 0
    ds_read_b128 v[200:203], v237 offset:0
    v_mfma_f32_16x16x32_bf16 v[100:103], v[204:207], a[144:147], 0
    buffer_load_dwordx4 v192, s[16:19], s35 offen offset:3072 lds
    s_mov_b32 s35, 81920
    s_add_u32 m0, s34, 81920
    v_mfma_f32_16x16x32_bf16 v[224:227], v[204:207], a[148:151], 0
    v_mfma_f32_16x16x32_bf16 v[228:231], v[204:207], a[152:155], 0
    buffer_load_dwordx4 v192, s[16:19], s35 offen offset:0 lds
    s_waitcnt vmcnt(9) lgkmcnt(0)
    s_barrier
    s_mov_b32 s35, 110592
    s_add_u32 m0, s34, 0
    ds_read_b64_tr_b16 a[24:25], v246 offset:0
    buffer_load_dwordx4 v191, s[16:19], s35 offen offset:0 lds
    buffer_load_dwordx4 v191, s[16:19], s35 offen offset:1024 lds
    buffer_load_dwordx4 v193, s[16:19], s35 offen offset:2048 lds
    buffer_load_dwordx4 v192, s[16:19], s35 offen offset:3072 lds
    ds_read_b64_tr_b16 a[26:27], v246 offset:4608
    ds_read_b64_tr_b16 a[28:29], v245 offset:0
    ds_read_b64_tr_b16 a[30:31], v245 offset:4608
    s_mov_b32 s35, 114688
    s_add_u32 m0, s34, 4096
    ds_read_b64_tr_b16 a[32:33], v3 offset:0
    buffer_load_dwordx4 v194, s[16:19], s35 offen offset:0 lds
    ds_read_b64_tr_b16 a[34:35], v3 offset:4608
    ds_read_b64_tr_b16 a[36:37], v246 offset:18432
    ds_read_b64_tr_b16 a[38:39], v246 offset:23040
    ds_read_b64_tr_b16 a[40:41], v245 offset:18432
    ds_read_b64_tr_b16 a[42:43], v245 offset:23040
    ds_read_b64_tr_b16 a[44:45], v3 offset:18432
    buffer_load_dwordx4 v191, s[16:19], s35 offen offset:1024 lds
    ds_read_b64_tr_b16 a[46:47], v3 offset:23040
    ds_read_b64_tr_b16 a[156:157], v188 offset:0
    ds_read_b64_tr_b16 a[158:159], v188 offset:4608
    ds_read_b64_tr_b16 a[160:161], v189 offset:0
    ds_read_b64_tr_b16 a[162:163], v189 offset:4608
    ds_read_b64_tr_b16 a[164:165], v190 offset:0
    ds_read_b64_tr_b16 a[166:167], v190 offset:4608
    ds_read_b128 v[204:207], v236 offset:6144
    v_add_u32 v246, 36864, v246
    v_add_u32 v245, 36864, v245
    s_waitcnt lgkmcnt(15)
    v_mfma_f32_32x32x16_bf16 v[104:119], a[24:27], v[208:211], v[104:119]
    v_add_u32 v3, 36864, v3
    v_add_u32 v188, 36864, v188
    v_add_u32 v189, 36864, v189
    v_add_u32 v190, 36864, v190
    v_mfma_f32_32x32x16_bf16 v[120:135], a[28:31], v[208:211], v[120:135]
    buffer_load_dwordx4 v195, s[16:19], s35 offen offset:2048 lds
    s_waitcnt lgkmcnt(13)
    v_mfma_f32_32x32x16_bf16 v[136:151], a[32:35], v[208:211], v[136:151]
    ds_read_b128 v[208:211], v237 offset:12288
    v_mfma_f32_32x32x16_bf16 v[40:55], a[24:27], v[212:215], v[40:55]
    buffer_load_dwordx4 v192, s[16:19], s35 offen offset:3072 lds
    s_mov_b32 s35, 118784
    s_add_u32 m0, s34, 8192
    v_mfma_f32_32x32x16_bf16 v[56:71], a[28:31], v[212:215], v[56:71]
    v_mfma_f32_32x32x16_bf16 v[72:87], a[32:35], v[212:215], v[72:87]
    buffer_load_dwordx4 v192, s[16:19], s35 offen offset:0 lds
    s_mov_b32 s35, 147456
    s_waitcnt lgkmcnt(1)
    v_mfma_f32_32x32x16_bf16 v[104:119], a[36:39], v[216:219], v[104:119]
    s_add_u32 m0, s34, 36864
    ds_read_b128 v[212:215], v236 offset:18432
    v_mfma_f32_32x32x16_bf16 v[120:135], a[40:43], v[216:219], v[120:135]
    s_waitcnt vmcnt(9) lgkmcnt(0)
    s_barrier
    ds_read_b64_tr_b16 a[48:49], v246 offset:0
    ds_read_b64_tr_b16 a[50:51], v246 offset:4608
    ds_read_b64_tr_b16 a[52:53], v245 offset:0
    v_mfma_f32_32x32x16_bf16 v[136:151], a[44:47], v[216:219], v[136:151]
    buffer_load_dwordx4 v191, s[16:19], s35 offen offset:0 lds
    ds_read_b128 v[216:219], v232 offset:1024
    ds_read_b64_tr_b16 a[54:55], v245 offset:4608
    v_mfma_f32_32x32x16_bf16 v[40:55], a[36:39], v[220:223], v[40:55]
    ds_read_b64_tr_b16 a[56:57], v3 offset:0
    ds_read_b64_tr_b16 a[58:59], v3 offset:4608
    buffer_load_dwordx4 v191, s[16:19], s35 offen offset:1024 lds
    v_mfma_f32_32x32x16_bf16 v[56:71], a[40:43], v[220:223], v[56:71]
    ds_read_b64_tr_b16 a[60:61], v246 offset:18432
    ds_read_b64_tr_b16 a[62:63], v246 offset:23040
    ds_read_b64_tr_b16 a[64:65], v245 offset:18432
    ds_read_b64_tr_b16 a[66:67], v245 offset:23040
    ds_read_b64_tr_b16 a[68:69], v3 offset:18432
    ds_read_b64_tr_b16 a[70:71], v3 offset:23040
    v_mfma_f32_32x32x16_bf16 v[72:87], a[44:47], v[220:223], v[72:87]
    buffer_load_dwordx4 v193, s[16:19], s35 offen offset:2048 lds
    ds_read_b128 v[220:223], v234 offset:4096
    ds_read_b64_tr_b16 a[168:169], v188 offset:0
    v_mfma_f32_16x16x32_bf16 v[152:155], v[200:203], a[156:159], v[152:155]
    ds_read_b64_tr_b16 a[170:171], v188 offset:4608
    ds_read_b64_tr_b16 a[172:173], v189 offset:0
    v_mfma_f32_16x16x32_bf16 v[156:159], v[200:203], a[160:163], v[156:159]
    ds_read_b64_tr_b16 a[174:175], v189 offset:4608
    ds_read_b64_tr_b16 a[176:177], v190 offset:0
    v_mfma_f32_16x16x32_bf16 v[160:163], v[200:203], a[164:167], v[160:163]
    ds_read_b128 v[200:203], v233 offset:1024
    ds_read_b64_tr_b16 a[178:179], v190 offset:4608
    v_mfma_f32_16x16x32_bf16 v[164:167], v[204:207], a[156:159], v[164:167]
    v_add_u32 v246, 4294893568, v246
    v_add_u32 v245, 4294893568, v245
    v_mfma_f32_16x16x32_bf16 v[168:171], v[204:207], a[160:163], v[168:171]
    buffer_load_dwordx4 v192, s[16:19], s35 offen offset:3072 lds
    v_mfma_f32_16x16x32_bf16 v[172:175], v[204:207], a[164:167], v[172:175]
    s_mov_b32 s35, 151552
    s_add_u32 m0, s34, 40960
    v_mfma_f32_16x16x32_bf16 v[88:91], v[208:211], a[156:159], v[88:91]
    ds_read_b128 v[204:207], v235 offset:4096
    v_add_u32 v3, 4294893568, v3
    v_mfma_f32_16x16x32_bf16 v[92:95], v[208:211], a[160:163], v[92:95]
    v_add_u32 v188, 4294893568, v188
    v_add_u32 v189, 4294893568, v189
    v_mfma_f32_16x16x32_bf16 v[96:99], v[208:211], a[164:167], v[96:99]
    buffer_load_dwordx4 v194, s[16:19], s35 offen offset:0 lds
    v_mfma_f32_16x16x32_bf16 v[100:103], v[212:215], a[156:159], v[100:103]
    ds_read_b128 v[208:211], v236 offset:1024
    v_add_u32 v190, 4294893568, v190
    v_mfma_f32_16x16x32_bf16 v[224:227], v[212:215], a[160:163], v[224:227]
    v_mfma_f32_16x16x32_bf16 v[228:231], v[212:215], a[164:167], v[228:231]
    ds_read_b128 v[212:215], v237 offset:7168
    s_waitcnt lgkmcnt(3)
    v_mfma_f32_32x32x16_bf16 v[104:119], a[48:51], v[216:219], v[104:119]
    buffer_load_dwordx4 v191, s[16:19], s35 offen offset:1024 lds
    v_mfma_f32_32x32x16_bf16 v[120:135], a[52:55], v[216:219], v[120:135]
    v_mfma_f32_32x32x16_bf16 v[136:151], a[56:59], v[216:219], v[136:151]
    buffer_load_dwordx4 v195, s[16:19], s35 offen offset:2048 lds
    ds_read_b128 v[216:219], v236 offset:13312
    v_mfma_f32_32x32x16_bf16 v[40:55], a[48:51], v[220:223], v[40:55]
    v_mfma_f32_32x32x16_bf16 v[56:71], a[52:55], v[220:223], v[56:71]
    buffer_load_dwordx4 v192, s[16:19], s35 offen offset:3072 lds
    s_mov_b32 s35, 155648
    s_add_u32 m0, s34, 45056
    v_mfma_f32_32x32x16_bf16 v[72:87], a[56:59], v[220:223], v[72:87]
    ds_read_b128 v[220:223], v237 offset:19456
    v_mfma_f32_32x32x16_bf16 v[104:119], a[60:63], v[200:203], v[104:119]
    buffer_load_dwordx4 v192, s[16:19], s35 offen offset:0 lds
    s_mov_b32 s35, 184320
    s_add_u32 m0, s34, 73728
    v_mfma_f32_32x32x16_bf16 v[120:135], a[64:67], v[200:203], v[120:135]
    s_waitcnt vmcnt(9) lgkmcnt(0)
    s_barrier
    ds_read_b64_tr_b16 a[72:73], v246 offset:0
    ds_read_b64_tr_b16 a[74:75], v246 offset:4608
    ds_read_b64_tr_b16 a[76:77], v245 offset:0
    v_mfma_f32_32x32x16_bf16 v[136:151], a[68:71], v[200:203], v[136:151]
    buffer_load_dwordx4 v191, s[16:19], s35 offen offset:0 lds
    ds_read_b128 v[200:203], v234 offset:1024
    ds_read_b64_tr_b16 a[78:79], v245 offset:4608
    v_mfma_f32_32x32x16_bf16 v[40:55], a[60:63], v[204:207], v[40:55]
    ds_read_b64_tr_b16 a[80:81], v3 offset:0
    ds_read_b64_tr_b16 a[82:83], v3 offset:4608
    buffer_load_dwordx4 v191, s[16:19], s35 offen offset:1024 lds
    v_mfma_f32_32x32x16_bf16 v[56:71], a[64:67], v[204:207], v[56:71]
    ds_read_b64_tr_b16 a[84:85], v246 offset:18432
    ds_read_b64_tr_b16 a[86:87], v246 offset:23040
    ds_read_b64_tr_b16 a[88:89], v245 offset:18432
    ds_read_b64_tr_b16 a[90:91], v245 offset:23040
    ds_read_b64_tr_b16 a[92:93], v3 offset:18432
    ds_read_b64_tr_b16 a[94:95], v3 offset:23040
    v_mfma_f32_32x32x16_bf16 v[72:87], a[68:71], v[204:207], v[72:87]
    buffer_load_dwordx4 v193, s[16:19], s35 offen offset:2048 lds
    ds_read_b128 v[204:207], v232 offset:4096
    ds_read_b64_tr_b16 a[180:181], v188 offset:0
    v_mfma_f32_16x16x32_bf16 v[152:155], v[208:211], a[168:171], v[152:155]
    ds_read_b64_tr_b16 a[182:183], v188 offset:4608
    ds_read_b64_tr_b16 a[184:185], v189 offset:0
    v_mfma_f32_16x16x32_bf16 v[156:159], v[208:211], a[172:175], v[156:159]
    ds_read_b64_tr_b16 a[186:187], v189 offset:4608
    ds_read_b64_tr_b16 a[188:189], v190 offset:0
    v_mfma_f32_16x16x32_bf16 v[160:163], v[208:211], a[176:179], v[160:163]
    ds_read_b128 v[208:211], v235 offset:1024
    ds_read_b64_tr_b16 a[190:191], v190 offset:4608
    v_mfma_f32_16x16x32_bf16 v[164:167], v[212:215], a[168:171], v[164:167]
    v_add_u32 v246, 36864, v246
    v_add_u32 v245, 36864, v245
    v_mfma_f32_16x16x32_bf16 v[168:171], v[212:215], a[172:175], v[168:171]
    buffer_load_dwordx4 v192, s[16:19], s35 offen offset:3072 lds
    v_mfma_f32_16x16x32_bf16 v[172:175], v[212:215], a[176:179], v[172:175]
    s_mov_b32 s35, 188416
    s_add_u32 m0, s34, 77824
    v_mfma_f32_16x16x32_bf16 v[88:91], v[216:219], a[168:171], v[88:91]
    ds_read_b128 v[212:215], v233 offset:4096
    v_add_u32 v3, 36864, v3
    v_mfma_f32_16x16x32_bf16 v[92:95], v[216:219], a[172:175], v[92:95]
    v_add_u32 v188, 36864, v188
    v_add_u32 v189, 36864, v189
    v_mfma_f32_16x16x32_bf16 v[96:99], v[216:219], a[176:179], v[96:99]
    buffer_load_dwordx4 v194, s[16:19], s35 offen offset:0 lds
    v_mfma_f32_16x16x32_bf16 v[100:103], v[220:223], a[168:171], v[100:103]
    ds_read_b128 v[216:219], v237 offset:1024
    v_add_u32 v190, 36864, v190
    v_mfma_f32_16x16x32_bf16 v[224:227], v[220:223], a[172:175], v[224:227]
    v_mfma_f32_16x16x32_bf16 v[228:231], v[220:223], a[176:179], v[228:231]
    ds_read_b128 v[220:223], v236 offset:7168
    s_waitcnt lgkmcnt(3)
    v_mfma_f32_32x32x16_bf16 v[104:119], a[72:75], v[200:203], v[104:119]
    buffer_load_dwordx4 v191, s[16:19], s35 offen offset:1024 lds
    v_mfma_f32_32x32x16_bf16 v[120:135], a[76:79], v[200:203], v[120:135]
    v_mfma_f32_32x32x16_bf16 v[136:151], a[80:83], v[200:203], v[136:151]
    buffer_load_dwordx4 v195, s[16:19], s35 offen offset:2048 lds
    ds_read_b128 v[200:203], v237 offset:13312
    v_mfma_f32_32x32x16_bf16 v[40:55], a[72:75], v[204:207], v[40:55]
    v_mfma_f32_32x32x16_bf16 v[56:71], a[76:79], v[204:207], v[56:71]
    buffer_load_dwordx4 v192, s[16:19], s35 offen offset:3072 lds
    s_mov_b32 s35, 192512
    s_add_u32 m0, s34, 81920
    v_mfma_f32_32x32x16_bf16 v[72:87], a[80:83], v[204:207], v[72:87]
    ds_read_b128 v[204:207], v236 offset:19456
    v_mfma_f32_32x32x16_bf16 v[104:119], a[84:87], v[208:211], v[104:119]
    buffer_load_dwordx4 v192, s[16:19], s35 offen offset:0 lds
    s_add_u32 m0, s31, 24576
    s_mov_b32 s35, 0
    v_mfma_f32_32x32x16_bf16 v[120:135], a[88:91], v[208:211], v[120:135]
    s_waitcnt vmcnt(9) lgkmcnt(0)
    s_barrier
    ds_read_b64_tr_b16 a[96:97], v246 offset:0
    ds_read_b64_tr_b16 a[98:99], v246 offset:4608
    ds_read_b64_tr_b16 a[100:101], v245 offset:0
    v_mfma_f32_32x32x16_bf16 v[136:151], a[92:95], v[208:211], v[136:151]
    buffer_load_dwordx4 v242, s[4:7], s36 offen offset:0 lds
    s_add_u32 m0, s31, 25472
    ds_read_b128 v[208:211], v232 offset:2048
    v_mfma_f32_32x32x16_bf16 v[40:55], a[84:87], v[212:215], v[40:55]
    ds_read_b64_tr_b16 a[102:103], v245 offset:4608
    ds_read_b64_tr_b16 a[104:105], v3 offset:0
    ds_read_b64_tr_b16 a[106:107], v3 offset:4608
    ds_read_b64_tr_b16 a[108:109], v246 offset:18432
    ds_read_b64_tr_b16 a[110:111], v246 offset:23040
    ds_read_b64_tr_b16 a[112:113], v245 offset:18432
    v_mfma_f32_32x32x16_bf16 v[56:71], a[88:91], v[212:215], v[56:71]
    buffer_load_dwordx4 v242, s[4:7], s36 offen offset:128 lds
    s_add_u32 m0, s31, 26368
    ds_read_b64_tr_b16 a[114:115], v245 offset:23040
    v_mfma_f32_32x32x16_bf16 v[72:87], a[92:95], v[212:215], v[72:87]
    ds_read_b128 v[212:215], v234 offset:5120
    ds_read_b64_tr_b16 a[116:117], v3 offset:18432
    ds_read_b64_tr_b16 a[118:119], v3 offset:23040
    ds_read_b64_tr_b16 a[192:193], v188 offset:0
    ds_read_b64_tr_b16 a[194:195], v188 offset:4608
    ds_read_b64_tr_b16 a[196:197], v189 offset:0
    v_mfma_f32_16x16x32_bf16 v[152:155], v[216:219], a[180:183], v[152:155]
    ds_read_b64_tr_b16 a[198:199], v189 offset:4608
    ds_read_b64_tr_b16 a[200:201], v190 offset:0
    v_mfma_f32_16x16x32_bf16 v[156:159], v[216:219], a[184:187], v[156:159]
    ds_read_b64_tr_b16 a[202:203], v190 offset:4608
    v_add_u32 v246, 36864, v246
    v_mfma_f32_16x16x32_bf16 v[160:163], v[216:219], a[188:191], v[160:163]
    ds_read_b128 v[216:219], v233 offset:2048
    v_add_u32 v245, 36864, v245
    v_mfma_f32_16x16x32_bf16 v[164:167], v[220:223], a[180:183], v[164:167]
    v_add_u32 v3, 36864, v3
    v_add_u32 v188, 36864, v188
    v_mfma_f32_16x16x32_bf16 v[168:171], v[220:223], a[184:187], v[168:171]
    buffer_load_dwordx4 v242, s[4:7], s36 offen offset:256 lds
    v_mfma_f32_16x16x32_bf16 v[172:175], v[220:223], a[188:191], v[172:175]
    s_add_u32 m0, s31, 36864
    ds_read_b128 v[220:223], v235 offset:5120
    v_mfma_f32_16x16x32_bf16 v[88:91], v[200:203], a[180:183], v[88:91]
    v_add_u32 v189, 36864, v189
    v_add_u32 v190, 36864, v190
    v_mfma_f32_16x16x32_bf16 v[92:95], v[200:203], a[184:187], v[92:95]
    v_readlane_b32 s36, v244, 2
    v_mfma_f32_16x16x32_bf16 v[96:99], v[200:203], a[188:191], v[96:99]
    ds_read_b128 v[200:203], v236 offset:2048
    v_mfma_f32_16x16x32_bf16 v[100:103], v[204:207], a[180:183], v[100:103]
    v_mfma_f32_16x16x32_bf16 v[224:227], v[204:207], a[184:187], v[224:227]
    buffer_load_dwordx4 v242, s[4:7], s37 offen offset:0 lds
    v_mfma_f32_16x16x32_bf16 v[228:231], v[204:207], a[188:191], v[228:231]
    s_add_u32 m0, s31, 37760
    s_waitcnt lgkmcnt(2)
    v_mfma_f32_32x32x16_bf16 v[104:119], a[96:99], v[208:211], v[104:119]
    ds_read_b128 v[204:207], v237 offset:8192
    v_mfma_f32_32x32x16_bf16 v[120:135], a[100:103], v[208:211], v[120:135]
    buffer_load_dwordx4 v242, s[4:7], s37 offen offset:128 lds
    s_add_u32 m0, s31, 38656
    v_mfma_f32_32x32x16_bf16 v[136:151], a[104:107], v[208:211], v[136:151]
    ds_read_b128 v[208:211], v236 offset:14336
    v_mfma_f32_32x32x16_bf16 v[40:55], a[96:99], v[212:215], v[40:55]
    v_mfma_f32_32x32x16_bf16 v[56:71], a[100:103], v[212:215], v[56:71]
    buffer_load_dwordx4 v242, s[4:7], s37 offen offset:256 lds
    s_add_u32 m0, s34, 0
    v_mad_i32_i24 v242, v243, s38, v242
    v_mfma_f32_32x32x16_bf16 v[72:87], a[104:107], v[212:215], v[72:87]
    ds_read_b128 v[212:215], v237 offset:20480
    v_readlane_b32 s37, v244, 18
    v_mfma_f32_32x32x16_bf16 v[104:119], a[108:111], v[216:219], v[104:119]
    v_mfma_f32_32x32x16_bf16 v[120:135], a[112:115], v[216:219], v[120:135]
    s_waitcnt vmcnt(6) lgkmcnt(0)
    s_barrier
    ds_read_b64_tr_b16 a[120:121], v246 offset:0
    ds_read_b64_tr_b16 a[122:123], v246 offset:4608
    ds_read_b64_tr_b16 a[124:125], v245 offset:0
    v_mfma_f32_32x32x16_bf16 v[136:151], a[116:119], v[216:219], v[136:151]
    buffer_load_dwordx4 v255, s[20:23], s35 offen offset:0 lds
    ds_read_b128 v[216:219], v234 offset:2048
    ds_read_b64_tr_b16 a[126:127], v245 offset:4608
    v_mfma_f32_32x32x16_bf16 v[40:55], a[108:111], v[220:223], v[40:55]
    ds_read_b64_tr_b16 a[128:129], v3 offset:0
    ds_read_b64_tr_b16 a[130:131], v3 offset:4608
    buffer_load_dwordx4 v2, s[20:23], s35 offen offset:1024 lds
    v_mfma_f32_32x32x16_bf16 v[56:71], a[112:115], v[220:223], v[56:71]
    ds_read_b64_tr_b16 a[132:133], v246 offset:18432
    ds_read_b64_tr_b16 a[134:135], v246 offset:23040
    ds_read_b64_tr_b16 a[136:137], v245 offset:18432
    ds_read_b64_tr_b16 a[138:139], v245 offset:23040
    ds_read_b64_tr_b16 a[140:141], v3 offset:18432
    ds_read_b64_tr_b16 a[142:143], v3 offset:23040
    v_mfma_f32_32x32x16_bf16 v[72:87], a[116:119], v[220:223], v[72:87]
    buffer_load_dwordx4 v0, s[20:23], s35 offen offset:2048 lds
    ds_read_b128 v[220:223], v232 offset:5120
    ds_read_b64_tr_b16 a[204:205], v188 offset:0
    v_mfma_f32_16x16x32_bf16 v[152:155], v[200:203], a[192:195], v[152:155]
    ds_read_b64_tr_b16 a[206:207], v188 offset:4608
    ds_read_b64_tr_b16 a[208:209], v189 offset:0
    v_mfma_f32_16x16x32_bf16 v[156:159], v[200:203], a[196:199], v[156:159]
    ds_read_b64_tr_b16 a[210:211], v189 offset:4608
    ds_read_b64_tr_b16 a[212:213], v190 offset:0
    v_mfma_f32_16x16x32_bf16 v[160:163], v[200:203], a[200:203], v[160:163]
    ds_read_b128 v[200:203], v235 offset:2048
    ds_read_b64_tr_b16 a[214:215], v190 offset:4608
    v_mfma_f32_16x16x32_bf16 v[164:167], v[204:207], a[192:195], v[164:167]
    v_mov_b32 v245, s40
    v_cndmask_b32 v245, 0, v245, s[42:43]
    v_mfma_f32_16x16x32_bf16 v[168:171], v[204:207], a[196:199], v[168:171]
    buffer_load_dwordx4 v255, s[20:23], s35 offen offset:3072 lds
    v_mfma_f32_16x16x32_bf16 v[172:175], v[204:207], a[200:203], v[172:175]
    s_mov_b32 s35, 4096
    s_add_u32 m0, s34, 4096
    v_mfma_f32_16x16x32_bf16 v[88:91], v[208:211], a[192:195], v[88:91]
    ds_read_b128 v[204:207], v233 offset:5120
    v_mfma_f32_16x16x32_bf16 v[92:95], v[208:211], a[196:199], v[92:95]
    v_mfma_f32_16x16x32_bf16 v[96:99], v[208:211], a[200:203], v[96:99]
    buffer_load_dwordx4 v2, s[20:23], s35 offen offset:0 lds
    v_mfma_f32_16x16x32_bf16 v[100:103], v[212:215], a[192:195], v[100:103]
    ds_read_b128 v[208:211], v237 offset:2048
    v_mfma_f32_16x16x32_bf16 v[224:227], v[212:215], a[196:199], v[224:227]
    v_mfma_f32_16x16x32_bf16 v[228:231], v[212:215], a[200:203], v[228:231]
    ds_read_b128 v[212:215], v236 offset:8192
    s_waitcnt lgkmcnt(3)
    v_mfma_f32_32x32x16_bf16 v[104:119], a[120:123], v[216:219], v[104:119]
    buffer_load_dwordx4 v0, s[20:23], s35 offen offset:1024 lds
    v_mfma_f32_32x32x16_bf16 v[120:135], a[124:127], v[216:219], v[120:135]
    v_mfma_f32_32x32x16_bf16 v[136:151], a[128:131], v[216:219], v[136:151]
    buffer_load_dwordx4 v255, s[20:23], s35 offen offset:2048 lds
    ds_read_b128 v[216:219], v237 offset:14336
    v_mfma_f32_32x32x16_bf16 v[40:55], a[120:123], v[220:223], v[40:55]
    v_mfma_f32_32x32x16_bf16 v[56:71], a[124:127], v[220:223], v[56:71]
    buffer_load_dwordx4 v2, s[20:23], s35 offen offset:3072 lds
    s_mov_b32 s35, 8192
    s_add_u32 m0, s34, 8192
    v_mfma_f32_32x32x16_bf16 v[72:87], a[128:131], v[220:223], v[72:87]
    ds_read_b128 v[220:223], v236 offset:20480
    v_mfma_f32_32x32x16_bf16 v[104:119], a[132:135], v[200:203], v[104:119]
    buffer_load_dwordx4 v0, s[20:23], s35 offen offset:0 lds
    s_mov_b32 s35, 36864
    s_add_u32 m0, s34, 36864
    v_mfma_f32_32x32x16_bf16 v[120:135], a[136:139], v[200:203], v[120:135]
    v_mfma_f32_32x32x16_bf16 v[136:151], a[140:143], v[200:203], v[136:151]
    s_waitcnt lgkmcnt(1)
    v_mfma_f32_32x32x16_bf16 v[40:55], a[132:135], v[204:207], v[40:55]
    v_mfma_f32_32x32x16_bf16 v[56:71], a[136:139], v[204:207], v[56:71]
    v_mfma_f32_32x32x16_bf16 v[72:87], a[140:143], v[204:207], v[72:87]
    v_mfma_f32_16x16x32_bf16 v[152:155], v[208:211], a[204:207], v[152:155]
    v_mfma_f32_16x16x32_bf16 v[156:159], v[208:211], a[208:211], v[156:159]
    v_mfma_f32_16x16x32_bf16 v[160:163], v[208:211], a[212:215], v[160:163]
    v_cvt_pk_bf16_f32 v104, v104, v105
    v_cvt_pk_bf16_f32 v105, v106, v107
    v_mfma_f32_16x16x32_bf16 v[164:167], v[212:215], a[204:207], v[164:167]
    v_cvt_pk_bf16_f32 v107, v110, v111
    v_cvt_pk_bf16_f32 v110, v116, v117
    v_mfma_f32_16x16x32_bf16 v[168:171], v[212:215], a[208:211], v[168:171]
    v_cvt_pk_bf16_f32 v111, v118, v119
    v_cvt_pk_bf16_f32 v106, v108, v109
    v_mfma_f32_16x16x32_bf16 v[172:175], v[212:215], a[212:215], v[172:175]
    s_waitcnt vmcnt(9) lgkmcnt(0)
    v_cvt_pk_bf16_f32 v116, v128, v129
    v_mfma_f32_16x16x32_bf16 v[88:91], v[216:219], a[204:207], v[88:91]
    s_barrier
    v_mfma_f32_16x16x32_bf16 v[92:95], v[216:219], a[208:211], v[92:95]
    v_cvt_pk_bf16_f32 v117, v130, v131
    v_cvt_pk_bf16_f32 v118, v132, v133
    v_mfma_f32_16x16x32_bf16 v[96:99], v[216:219], a[212:215], v[96:99]
    v_cvt_pk_bf16_f32 v119, v134, v135
    v_cvt_pk_bf16_f32 v128, v40, v41
    v_mfma_f32_16x16x32_bf16 v[100:103], v[220:223], a[204:207], v[100:103]
    buffer_load_dwordx4 v255, s[20:23], s35 offen offset:0 lds
    v_mfma_f32_16x16x32_bf16 v[224:227], v[220:223], a[208:211], v[224:227]
    v_cvt_pk_bf16_f32 v129, v42, v43
    v_cvt_pk_bf16_f32 v130, v44, v45
    v_mfma_f32_16x16x32_bf16 v[228:231], v[220:223], a[212:215], v[228:231]
    buffer_load_dwordx4 v2, s[20:23], s35 offen offset:1024 lds
    v_cvt_pk_bf16_f32 v131, v46, v47
    v_cvt_pk_bf16_f32 v132, v48, v49
    v_cvt_pk_bf16_f32 v133, v50, v51
    v_cvt_pk_bf16_f32 v134, v52, v53
    v_cvt_pk_bf16_f32 v135, v54, v55
    v_mfma_f32_32x32x16_bf16 v[40:55], v[116:119], v[104:107], v[4:19]
    v_cvt_pk_bf16_f32 v108, v112, v113
    v_cvt_pk_bf16_f32 v113, v122, v123
    v_cvt_pk_bf16_f32 v122, v140, v141
    v_cvt_pk_bf16_f32 v123, v142, v143
    v_cvt_pk_bf16_f32 v112, v120, v121
    v_cvt_pk_bf16_f32 v140, v64, v65
    v_cvt_pk_bf16_f32 v141, v66, v67
    v_cvt_pk_bf16_f32 v142, v68, v69
    v_cvt_pk_bf16_f32 v143, v70, v71
    v_cvt_pk_bf16_f32 v120, v136, v137
    v_cvt_pk_bf16_f32 v121, v138, v139
    v_cvt_pk_bf16_f32 v136, v56, v57
    v_cvt_pk_bf16_f32 v137, v58, v59
    v_cvt_pk_bf16_f32 v138, v60, v61
    v_cvt_pk_bf16_f32 v139, v62, v63
    v_mfma_f32_32x32x16_bf16 v[56:71], v[140:143], v[104:107], v[24:39]
    buffer_load_dwordx4 v0, s[20:23], s35 offen offset:2048 lds
    v_cvt_pk_bf16_f32 v109, v114, v115
    v_cvt_pk_bf16_f32 v114, v124, v125
    v_cvt_pk_bf16_f32 v124, v144, v145
    v_mfma_f32_32x32x16_bf16 v[40:55], v[120:123], v[108:111], v[40:55]
    v_cvt_pk_bf16_f32 v125, v146, v147
    v_cvt_pk_bf16_f32 v144, v72, v73
    v_cvt_pk_bf16_f32 v145, v74, v75
    v_cvt_pk_bf16_f32 v146, v76, v77
    v_cvt_pk_bf16_f32 v147, v78, v79
    buffer_load_dwordx4 v255, s[20:23], s35 offen offset:3072 lds
    v_cvt_pk_bf16_f32 v115, v126, v127
    v_mfma_f32_32x32x16_bf16 v[56:71], v[144:147], v[108:111], v[56:71]
    v_cvt_pk_bf16_f32 v126, v148, v149
    v_cvt_pk_bf16_f32 v127, v150, v151
    s_mov_b32 s35, 40960
    s_add_u32 m0, s34, 40960
    v_cvt_pk_bf16_f32 v148, v80, v81
    v_cvt_pk_bf16_f32 v149, v82, v83
    v_mfma_f32_32x32x16_bf16 v[40:55], v[124:127], v[112:115], v[40:55]
    buffer_load_dwordx4 v2, s[20:23], s35 offen offset:0 lds
    v_cvt_pk_bf16_f32 v150, v84, v85
    v_cvt_pk_bf16_f32 v151, v86, v87
    v_cvt_pk_bf16_f32 v188, v88, v89
    v_cvt_pk_bf16_f32 v189, v90, v91
    v_mfma_f32_32x32x16_bf16 v[56:71], v[148:151], v[112:115], v[56:71]
    buffer_load_dwordx4 v0, s[20:23], s35 offen offset:1024 lds
    v_cvt_pk_bf16_f32 v192, v92, v93
    v_cvt_pk_bf16_f32 v193, v94, v95
    v_mfma_f32_32x32x16_bf16 v[72:87], v[116:119], v[128:131], v[20:35]
    v_cvt_pk_bf16_f32 v196, v96, v97
    v_cvt_pk_bf16_f32 v197, v98, v99
    v_cvt_pk_bf16_f32 v190, v100, v101
    v_cvt_pk_bf16_f32 v191, v102, v103
    ds_read_b128 v[200:203], v232 offset:24576
    ds_read_b128 v[204:207], v233 offset:24576
    v_mfma_f32_32x32x16_bf16 v[88:103], v[140:143], v[128:131], v[4:19]
    buffer_load_dwordx4 v255, s[20:23], s35 offen offset:2048 lds
    ds_read_b128 v[208:211], v234 offset:24576
    ds_read_b128 v[212:215], v235 offset:24576
    v_mfma_f32_32x32x16_bf16 v[72:87], v[120:123], v[132:135], v[72:87]
    ds_read_b128 v[216:219], v232 offset:25600
    ds_read_b128 v[220:223], v233 offset:25600
    buffer_load_dwordx4 v2, s[20:23], s35 offen offset:3072 lds
    v_mfma_f32_32x32x16_bf16 v[88:103], v[144:147], v[132:135], v[88:103]
    s_mov_b32 s35, 45056
    s_add_u32 m0, s34, 45056
    v_accvgpr_read_b32 v255, a252
    v_accvgpr_read_b32 v2, a253
    v_add_u32 v255, 36864, v255
    v_cvt_pk_bf16_f32 v176, v152, v153
    v_mfma_f32_32x32x16_bf16 v[72:87], v[124:127], v[136:139], v[72:87]
    buffer_load_dwordx4 v0, s[20:23], s35 offen offset:0 lds
    v_cvt_pk_bf16_f32 v177, v154, v155
    v_cvt_pk_bf16_f32 v180, v156, v157
    v_mfma_f32_32x32x16_bf16 v[88:103], v[148:151], v[136:139], v[88:103]
    v_add_u32 v2, 36864, v2
    s_add_u32 m0, s31, 0
    v_cvt_pk_bf16_f32 v181, v158, v159
    v_cvt_pk_bf16_f32 v184, v160, v161
    v_cvt_pk_bf16_f32 v185, v162, v163
    s_waitcnt lgkmcnt(4)
    v_mfma_f32_32x32x16_bf16 v[104:119], a[0:3], v[200:203], 0
    v_cvt_pk_bf16_f32 v178, v164, v165
    v_cvt_pk_bf16_f32 v179, v166, v167
    v_cvt_pk_bf16_f32 v182, v168, v169
    v_cvt_pk_bf16_f32 v183, v170, v171
    v_cvt_pk_bf16_f32 v186, v172, v173
    v_cvt_pk_bf16_f32 v187, v174, v175
    v_mfma_f32_32x32x16_bf16 v[120:135], a[4:7], v[200:203], 0
    v_cvt_pk_bf16_f32 v194, v224, v225
    v_cvt_pk_bf16_f32 v195, v226, v227
    v_cvt_pk_bf16_f32 v198, v228, v229
    v_max3_f32 v246, v40, v41, v42
    v_max3_f32 v246, v246, v43, v44
    v_max3_f32 v246, v246, v45, v46
    v_mfma_f32_32x32x16_bf16 v[136:151], a[8:11], v[200:203], 0
    ds_read_b128 v[200:203], v234 offset:25600
    v_cvt_pk_bf16_f32 v199, v230, v231
    v_max3_f32 v246, v246, v47, v48
    v_max3_f32 v246, v246, v49, v50
    v_max3_f32 v246, v246, v51, v52
    v_max3_f32 v246, v246, v53, v54
    v_mfma_f32_32x32x16_bf16 v[104:119], a[12:15], v[204:207], v[104:119]
    v_max3_f32 v246, v246, v55, v56
    v_max3_f32 v246, v246, v57, v58
    v_max3_f32 v246, v246, v59, v60
    v_max3_f32 v246, v246, v61, v62
    v_max3_f32 v246, v246, v63, v64
    v_max3_f32 v246, v246, v65, v66
    v_mfma_f32_32x32x16_bf16 v[120:135], a[16:19], v[204:207], v[120:135]
    v_max3_f32 v246, v246, v67, v68
    v_max3_f32 v246, v246, v69, v70
    v_max_f32 v246, v246, v71
    v_fma_f32 v246, v246, s29, v245
    v_mov_b32 v1, v246
    v_mfma_f32_32x32x16_bf16 v[136:151], a[20:23], v[204:207], v[136:151]
    ds_read_b128 v[204:207], v235 offset:25600
    v_permlane32_swap_b32 v246, v1
    v_max_f32 v246, v246, v1
    v_sub_f32 v246, v245, v246
    v_fma_f32 v40, v40, s29, v246
    s_waitcnt lgkmcnt(2)
    v_mfma_f32_32x32x16_bf16 v[104:119], a[24:27], v[208:211], v[104:119]
    v_fma_f32 v41, v41, s29, v246
    v_exp_f32 v40, v40
    v_exp_f32 v41, v41
    v_fma_f32 v56, v56, s29, v246
    v_mfma_f32_32x32x16_bf16 v[120:135], a[28:31], v[208:211], v[120:135]
    v_exp_f32 v56, v56
    v_fma_f32 v57, v57, s29, v246
    v_exp_f32 v57, v57
    v_fma_f32 v42, v42, s29, v246
    v_mfma_f32_32x32x16_bf16 v[136:151], a[32:35], v[208:211], v[136:151]
    ds_read_b128 v[208:211], v232 offset:26624
    v_add_f32 v0, v40, v41
    v_exp_f32 v42, v42
    v_fma_f32 v43, v43, s29, v246
    v_add_f32 v0, v0, v56
    v_mfma_f32_32x32x16_bf16 v[104:119], a[36:39], v[212:215], v[104:119]
    v_exp_f32 v43, v43
    v_fma_f32 v58, v58, s29, v246
    v_add_f32 v0, v0, v57
    v_exp_f32 v58, v58
    v_mfma_f32_32x32x16_bf16 v[120:135], a[40:43], v[212:215], v[120:135]
    v_fma_f32 v59, v59, s29, v246
    v_add_f32 v0, v0, v42
    v_exp_f32 v59, v59
    v_fma_f32 v44, v44, s29, v246
    v_add_f32 v0, v0, v43
    v_mfma_f32_32x32x16_bf16 v[136:151], a[44:47], v[212:215], v[136:151]
    ds_read_b128 v[212:215], v233 offset:26624
    v_exp_f32 v44, v44
    v_fma_f32 v45, v45, s29, v246
    v_add_f32 v0, v0, v58
    v_fma_f32 v60, v60, s29, v246
    v_mfma_f32_32x32x16_bf16 v[104:119], a[48:51], v[216:219], v[104:119]
    v_exp_f32 v45, v45
    v_add_f32 v0, v0, v59
    v_exp_f32 v60, v60
    v_fma_f32 v61, v61, s29, v246
    v_mfma_f32_32x32x16_bf16 v[120:135], a[52:55], v[216:219], v[120:135]
    v_add_f32 v0, v0, v44
    v_exp_f32 v61, v61
    v_fma_f32 v46, v46, s29, v246
    v_add_f32 v0, v0, v45
    v_fma_f32 v47, v47, s29, v246
    v_mfma_f32_32x32x16_bf16 v[136:151], a[56:59], v[216:219], v[136:151]
    ds_read_b128 v[216:219], v234 offset:26624
    v_exp_f32 v46, v46
    v_add_f32 v0, v0, v60
    v_exp_f32 v47, v47
    v_mfma_f32_32x32x16_bf16 v[104:119], a[60:63], v[220:223], v[104:119]
    v_fma_f32 v62, v62, s29, v246
    v_add_f32 v0, v0, v61
    v_exp_f32 v62, v62
    v_fma_f32 v63, v63, s29, v246
    v_add_f32 v0, v0, v46
    v_mfma_f32_32x32x16_bf16 v[120:135], a[64:67], v[220:223], v[120:135]
    v_exp_f32 v63, v63
    v_fma_f32 v48, v48, s29, v246
    v_add_f32 v0, v0, v47
    v_exp_f32 v48, v48
    v_mfma_f32_32x32x16_bf16 v[136:151], a[68:71], v[220:223], v[136:151]
    s_waitcnt vmcnt(0) lgkmcnt(0)
    s_barrier
    ds_read_b64_tr_b16 a[252:253], v255 offset:0
    ds_read_b64_tr_b16 a[254:255], v255 offset:6144
    ds_read_b64_tr_b16 v[152:153], v255 offset:8
    v_mfma_f32_32x32x16_bf16 v[104:119], a[72:75], v[200:203], v[104:119]
    ds_read_b64_tr_b16 v[154:155], v255 offset:6152
    ds_read_b64_tr_b16 v[156:157], v2 offset:0
    ds_read_b64_tr_b16 v[158:159], v2 offset:6144
    ds_read_b64_tr_b16 v[160:161], v255 offset:18432
    ds_read_b64_tr_b16 v[162:163], v255 offset:24576
    ds_read_b64_tr_b16 v[164:165], v255 offset:18440
    v_mfma_f32_32x32x16_bf16 v[120:135], a[76:79], v[200:203], v[120:135]
    ds_read_b64_tr_b16 v[166:167], v255 offset:24584
    ds_read_b64_tr_b16 v[168:169], v2 offset:18432
    ds_read_b64_tr_b16 v[170:171], v2 offset:24576
    ds_read_b64_tr_b16 v[172:173], v255 offset:12288
    ds_read_b64_tr_b16 v[174:175], v255 offset:30720
    ds_read_b64_tr_b16 v[224:225], v255 offset:12296
    v_mfma_f32_32x32x16_bf16 v[136:151], a[80:83], v[200:203], v[136:151]
    buffer_load_dwordx4 v242, s[4:7], s36 offen offset:0 lds
    s_add_u32 m0, s31, 896
    ds_read_b64_tr_b16 v[226:227], v255 offset:30728
    v_mfma_f32_32x32x16_bf16 v[104:119], a[84:87], v[204:207], v[104:119]
    ds_read_b128 v[220:223], v235 offset:26624
    ds_read_b64_tr_b16 v[228:229], v2 offset:12288
    ds_read_b64_tr_b16 v[230:231], v2 offset:30720
    v_add_u32 v255, 4294930432, v255
    ds_read_b64_tr_b16 a[216:217], v255 offset:0
    ds_read_b64_tr_b16 a[218:219], v255 offset:6144
    v_mfma_f32_32x32x16_bf16 v[120:135], a[88:91], v[204:207], v[120:135]
    ds_read_b64_tr_b16 a[220:221], v255 offset:8
    ds_read_b64_tr_b16 a[222:223], v255 offset:6152
    v_add_u32 v2, 4294930432, v2
    ds_read_b64_tr_b16 a[224:225], v2 offset:0
    v_fma_f32 v49, v49, s29, v246
    v_add_f32 v0, v0, v62
    v_mfma_f32_32x32x16_bf16 v[136:151], a[92:95], v[204:207], v[136:151]
    v_exp_f32 v49, v49
    v_fma_f32 v64, v64, s29, v246
    v_add_f32 v0, v0, v63
    v_exp_f32 v64, v64
    v_mfma_f32_32x32x16_bf16 v[104:119], a[96:99], v[208:211], v[104:119]
    buffer_load_dwordx4 v242, s[4:7], s36 offen offset:128 lds
    s_add_u32 m0, s31, 1792
    v_fma_f32 v65, v65, s29, v246
    v_mfma_f32_32x32x16_bf16 v[120:135], a[100:103], v[208:211], v[120:135]
    ds_read_b64_tr_b16 a[226:227], v2 offset:6144
    v_add_f32 v0, v0, v48
    v_exp_f32 v65, v65
    v_fma_f32 v50, v50, s29, v246
    v_add_f32 v0, v0, v49
    v_mfma_f32_32x32x16_bf16 v[136:151], a[104:107], v[208:211], v[136:151]
    v_exp_f32 v50, v50
    v_fma_f32 v51, v51, s29, v246
    v_add_f32 v0, v0, v64
    v_exp_f32 v51, v51
    v_mfma_f32_32x32x16_bf16 v[104:119], a[108:111], v[212:215], v[104:119]
    v_fma_f32 v66, v66, s29, v246
    v_add_f32 v0, v0, v65
    v_exp_f32 v66, v66
    v_fma_f32 v67, v67, s29, v246
    v_cvt_pk_bf16_f32 v40, v40, v41
    v_mfma_f32_32x32x16_bf16 v[120:135], a[112:115], v[212:215], v[120:135]
    buffer_load_dwordx4 v242, s[4:7], s36 offen offset:256 lds
    s_add_u32 m0, s31, 12288
    v_cvt_pk_bf16_f32 v56, v56, v57
    v_mfma_f32_32x32x16_bf16 v[136:151], a[116:119], v[212:215], v[136:151]
    s_waitcnt lgkmcnt(1)
    ds_write_b128 v241, v[152:155] offset:32768
    v_add_f32 v0, v0, v50
    v_exp_f32 v67, v67
    v_mfma_f32_32x32x16_bf16 v[104:119], a[120:123], v[216:219], v[104:119]
    v_fma_f32 v52, v52, s29, v246
    v_cvt_pk_bf16_f32 v41, v42, v43
    v_cvt_pk_bf16_f32 v57, v58, v59
    v_add_f32 v0, v0, v51
    v_exp_f32 v52, v52
    v_mfma_f32_32x32x16_bf16 v[120:135], a[124:127], v[216:219], v[120:135]
    v_fma_f32 v53, v53, s29, v246
    ds_read_b64_tr_b16 a[228:229], v255 offset:18432
    ds_write_b128 v241, v[156:159] offset:33792
    v_cvt_pk_bf16_f32 v42, v44, v45
    v_cvt_pk_bf16_f32 v58, v60, v61
    v_mfma_f32_32x32x16_bf16 v[136:151], a[128:131], v[216:219], v[136:151]
    buffer_load_dwordx4 v242, s[4:7], s37 offen offset:0 lds
    v_cvt_pk_bf16_f32 v43, v46, v47
    v_cvt_pk_bf16_f32 v59, v62, v63
    v_mfma_f32_32x32x16_bf16 v[104:119], a[132:135], v[220:223], v[104:119]
    v_add_f32 v0, v0, v66
    v_exp_f32 v53, v53
    v_fma_f32 v68, v68, s29, v246
    v_permlane16_swap_b32 v40, v56
    v_permlane16_swap_b32 v41, v57
    v_mfma_f32_32x32x16_bf16 v[120:135], a[136:139], v[220:223], v[120:135]
    v_permlane16_swap_b32 v42, v58
    v_permlane16_swap_b32 v43, v59
    v_add_f32 v0, v0, v67
    v_exp_f32 v68, v68
    v_fma_f32 v69, v69, s29, v246
    v_mfma_f32_32x32x16_bf16 v[136:151], a[140:143], v[220:223], v[136:151]
    ds_write_b128 v241, v[160:163] offset:34816
    v_add_f32 v0, v0, v52
    v_exp_f32 v69, v69
    v_fma_f32 v54, v54, s29, v246
    v_cvt_pk_bf16_f32 v44, v48, v49
    v_cvt_pk_bf16_f32 v45, v50, v51
    v_mfma_f32_16x16x32_bf16 v[48:51], v[176:179], v[40:43], 0
    v_add_f32 v0, v0, v53
    v_exp_f32 v54, v54
    v_fma_f32 v55, v55, s29, v246
    ds_write_b128 v241, v[164:167] offset:35840
    v_add_f32 v0, v0, v68
    v_exp_f32 v55, v55
    v_add_f32 v0, v0, v69
    ds_read_b64_tr_b16 a[230:231], v255 offset:24576
    ds_write_b128 v241, v[168:171] offset:36864
    v_add_f32 v0, v0, v54
    v_cvt_pk_bf16_f32 v46, v52, v53
    v_add_f32 v0, v0, v55
    v_cvt_pk_bf16_f32 v47, v54, v55
    v_mfma_f32_16x16x32_bf16 v[52:55], v[180:183], v[40:43], 0
    ds_write_b128 v241, v[172:175] offset:37888
    s_add_u32 m0, s31, 13184
    ds_write_b128 v241, v[224:227] offset:38912
    v_mfma_f32_16x16x32_bf16 v[224:227], v[184:187], v[40:43], 0
    buffer_load_dwordx4 v242, s[4:7], s37 offen offset:128 lds
    ds_read_b64_tr_b16 a[232:233], v255 offset:18440
    v_fma_f32 v70, v70, s29, v246
    v_cvt_pk_bf16_f32 v60, v64, v65
    v_cvt_pk_bf16_f32 v61, v66, v67
    v_mfma_f32_16x16x32_bf16 v[64:67], v[176:179], v[56:59], 0
    v_exp_f32 v70, v70
    v_fma_f32 v71, v71, s29, v246
    v_exp_f32 v71, v71
    ds_read_b64_tr_b16 a[234:235], v255 offset:24584
    v_add_f32 v0, v0, v70
    v_cvt_pk_bf16_f32 v62, v68, v69
    v_add_f32 v0, v0, v71
    v_cvt_pk_bf16_f32 v63, v70, v71
    v_mfma_f32_16x16x32_bf16 v[68:71], v[180:183], v[56:59], 0
    ds_write_b128 v241, v[228:231] offset:39936
    v_mfma_f32_16x16x32_bf16 v[228:231], v[184:187], v[56:59], 0
    ds_read_b128 v[200:203], v234 offset:27648
    ds_read_b64_tr_b16 a[236:237], v2 offset:18432
    v_permlane16_swap_b32 v44, v60
    v_permlane16_swap_b32 v45, v61
    v_permlane16_swap_b32 v46, v62
    v_permlane16_swap_b32 v47, v63
    ds_read_b64_tr_b16 a[238:239], v2 offset:24576
    ds_read_b64_tr_b16 a[240:241], v255 offset:12288
    v_mfma_f32_16x16x32_bf16 v[48:51], v[188:191], v[44:47], v[48:51]
    s_add_u32 m0, s31, 14080
    ds_read_b64_tr_b16 a[242:243], v255 offset:30720
    v_mfma_f32_16x16x32_bf16 v[52:55], v[192:195], v[44:47], v[52:55]
    v_cvt_pk_bf16_f32 v104, v104, v105
    ds_read_b128 v[204:207], v235 offset:27648
    v_mfma_f32_16x16x32_bf16 v[224:227], v[196:199], v[44:47], v[224:227]
    v_cvt_pk_bf16_f32 v105, v106, v107
    ds_read_b64_tr_b16 a[244:245], v255 offset:12296
    v_mfma_f32_16x16x32_bf16 v[64:67], v[188:191], v[60:63], v[64:67]
    v_cvt_pk_bf16_f32 v106, v108, v109
    v_cvt_pk_bf16_f32 v107, v110, v111
    v_mfma_f32_16x16x32_bf16 v[68:71], v[192:195], v[60:63], v[68:71]
    buffer_load_dwordx4 v242, s[4:7], s37 offen offset:256 lds
    v_mfma_f32_16x16x32_bf16 v[228:231], v[196:199], v[60:63], v[228:231]
    v_cvt_pk_bf16_f32 v108, v112, v113
    v_cvt_pk_bf16_f32 v110, v116, v117
    v_cvt_pk_bf16_f32 v111, v118, v119
    v_cvt_pk_bf16_f32 v112, v120, v121
    v_cvt_pk_bf16_f32 v113, v122, v123
    v_cvt_pk_bf16_f32 v116, v128, v129
    v_cvt_pk_bf16_f32 v117, v130, v131
    v_cvt_pk_bf16_f32 v118, v132, v133
    v_cvt_pk_bf16_f32 v119, v134, v135
    v_cvt_pk_bf16_f32 v120, v136, v137
    v_cvt_pk_bf16_f32 v121, v138, v139
    v_cvt_pk_bf16_f32 v122, v140, v141
    v_cvt_pk_bf16_f32 v123, v142, v143
    s_waitcnt lgkmcnt(5)
    v_mfma_f32_32x32x16_bf16 v[128:143], a[0:3], v[200:203], 0
    ds_read_b64_tr_b16 a[246:247], v255 offset:30728
    v_cvt_pk_bf16_f32 v109, v114, v115
    v_cvt_pk_bf16_f32 v114, v124, v125
    v_cvt_pk_bf16_f32 v115, v126, v127
    v_cvt_pk_bf16_f32 v124, v144, v145
    v_cvt_pk_bf16_f32 v125, v146, v147
    v_cvt_pk_bf16_f32 v126, v148, v149
    v_cvt_pk_bf16_f32 v127, v150, v151
    v_mfma_f32_32x32x16_bf16 v[144:159], a[4:7], v[200:203], 0
    ds_read_b64_tr_b16 a[248:249], v2 offset:12288
    ds_read_b64_tr_b16 a[250:251], v2 offset:30720
    ds_read_b128 v[208:211], v232 offset:27648
    ds_read_b128 v[212:215], v233 offset:27648
    ds_read_b128 v[216:219], v234 offset:28672
    ds_read_b128 v[220:223], v235 offset:28672
    v_mfma_f32_32x32x16_bf16 v[160:175], a[8:11], v[200:203], 0
    ds_read_b128 v[200:203], v232 offset:28672
    v_max3_f32 v246, v72, v73, v74
    v_max3_f32 v246, v246, v75, v76
    v_max3_f32 v246, v246, v77, v78
    v_max3_f32 v246, v246, v79, v80
    s_waitcnt lgkmcnt(8)
    v_mfma_f32_32x32x16_bf16 v[128:143], a[12:15], v[204:207], v[128:143]
    v_max3_f32 v246, v246, v81, v82
    v_max3_f32 v246, v246, v83, v84
    v_max3_f32 v246, v246, v85, v86
    v_max3_f32 v246, v246, v87, v88
    v_max3_f32 v246, v246, v89, v90
    v_max3_f32 v246, v246, v91, v92
    v_mfma_f32_32x32x16_bf16 v[144:159], a[16:19], v[204:207], v[144:159]
    v_max3_f32 v246, v246, v93, v94
    v_max3_f32 v246, v246, v95, v96
    v_max3_f32 v246, v246, v97, v98
    v_max3_f32 v246, v246, v99, v100
    v_max3_f32 v246, v246, v101, v102
    v_max_f32 v246, v246, v103
    v_mfma_f32_32x32x16_bf16 v[160:175], a[20:23], v[204:207], v[160:175]
    ds_read_b128 v[204:207], v233 offset:28672
    v_fma_f32 v246, v246, s29, v245
    v_mov_b32 v3, v246
    v_mov_b32 v1, v0
    ds_read_b128 v[56:59], v241 offset:32768
    s_waitcnt lgkmcnt(6)
    v_mfma_f32_32x32x16_bf16 v[128:143], a[24:27], v[208:211], v[128:143]
    v_permlane32_swap_b32 v246, v3
    v_max_f32 v246, v246, v3
    v_sub_f32 v246, v245, v246
    v_fma_f32 v72, v72, s29, v246
    v_fma_f32 v73, v73, s29, v246
    v_fma_f32 v88, v88, s29, v246
    v_mfma_f32_32x32x16_bf16 v[144:159], a[28:31], v[208:211], v[144:159]
    v_exp_f32 v72, v72
    v_exp_f32 v73, v73
    v_exp_f32 v88, v88
    v_mfma_f32_32x32x16_bf16 v[160:175], a[32:35], v[208:211], v[160:175]
    ds_read_b128 v[208:211], v234 offset:29696
    v_fma_f32 v89, v89, s29, v246
    v_exp_f32 v89, v89
    v_fma_f32 v74, v74, s29, v246
    s_waitcnt lgkmcnt(3)
    v_mfma_f32_32x32x16_bf16 v[128:143], a[36:39], v[212:215], v[128:143]
    v_add_f32 v2, v72, v73
    v_exp_f32 v74, v74
    v_fma_f32 v75, v75, s29, v246
    v_add_f32 v2, v2, v88
    v_fma_f32 v90, v90, s29, v246
    v_mfma_f32_32x32x16_bf16 v[144:159], a[40:43], v[212:215], v[144:159]
    v_exp_f32 v75, v75
    v_add_f32 v2, v2, v89
    v_exp_f32 v90, v90
    v_fma_f32 v91, v91, s29, v246
    v_mfma_f32_32x32x16_bf16 v[160:175], a[44:47], v[212:215], v[160:175]
    ds_read_b128 v[212:215], v235 offset:29696
    v_add_f32 v2, v2, v74
    v_exp_f32 v91, v91
    v_fma_f32 v76, v76, s29, v246
    v_add_f32 v2, v2, v75
    v_mfma_f32_32x32x16_bf16 v[128:143], a[48:51], v[216:219], v[128:143]
    v_exp_f32 v76, v76
    v_fma_f32 v77, v77, s29, v246
    v_add_f32 v2, v2, v90
    v_exp_f32 v77, v77
    v_mfma_f32_32x32x16_bf16 v[144:159], a[52:55], v[216:219], v[144:159]
    v_fma_f32 v92, v92, s29, v246
    v_add_f32 v2, v2, v91
    v_exp_f32 v92, v92
    v_fma_f32 v93, v93, s29, v246
    v_add_f32 v2, v2, v76
    v_mfma_f32_32x32x16_bf16 v[160:175], a[56:59], v[216:219], v[160:175]
    ds_read_b128 v[216:219], v232 offset:29696
    v_exp_f32 v93, v93
    v_fma_f32 v78, v78, s29, v246
    v_add_f32 v2, v2, v77
    v_fma_f32 v79, v79, s29, v246
    v_mfma_f32_32x32x16_bf16 v[128:143], a[60:63], v[220:223], v[128:143]
    v_exp_f32 v78, v78
    v_add_f32 v2, v2, v92
    v_exp_f32 v79, v79
    v_fma_f32 v94, v94, s29, v246
    v_mfma_f32_32x32x16_bf16 v[144:159], a[64:67], v[220:223], v[144:159]
    v_add_f32 v2, v2, v93
    v_exp_f32 v94, v94
    v_fma_f32 v95, v95, s29, v246
    v_add_f32 v2, v2, v78
    v_fma_f32 v80, v80, s29, v246
    v_mfma_f32_32x32x16_bf16 v[160:175], a[68:71], v[220:223], v[160:175]
    ds_read_b128 v[220:223], v233 offset:29696
    v_exp_f32 v95, v95
    v_add_f32 v2, v2, v79
    v_exp_f32 v80, v80
    v_mfma_f32_32x32x16_bf16 v[128:143], a[72:75], v[200:203], v[128:143]
    v_fma_f32 v81, v81, s29, v246
    v_add_f32 v2, v2, v94
    v_exp_f32 v81, v81
    v_fma_f32 v96, v96, s29, v246
    v_add_f32 v2, v2, v95
    v_mfma_f32_32x32x16_bf16 v[144:159], a[76:79], v[200:203], v[144:159]
    v_exp_f32 v96, v96
    v_fma_f32 v97, v97, s29, v246
    v_add_f32 v2, v2, v80
    v_exp_f32 v97, v97
    v_mfma_f32_32x32x16_bf16 v[160:175], a[80:83], v[200:203], v[160:175]
    v_fma_f32 v82, v82, s29, v246
    v_add_f32 v2, v2, v81
    v_exp_f32 v82, v82
    v_fma_f32 v83, v83, s29, v246
    s_waitcnt lgkmcnt(1)
    v_mfma_f32_32x32x16_bf16 v[128:143], a[84:87], v[204:207], v[128:143]
    v_add_f32 v2, v2, v96
    v_exp_f32 v83, v83
    v_fma_f32 v98, v98, s29, v246
    v_add_f32 v2, v2, v97
    v_fma_f32 v99, v99, s29, v246
    v_mfma_f32_32x32x16_bf16 v[144:159], a[88:91], v[204:207], v[144:159]
    v_exp_f32 v98, v98
    v_cvt_pk_bf16_f32 v72, v72, v73
    v_cvt_pk_bf16_f32 v88, v88, v89
    v_add_f32 v2, v2, v82
    v_fma_f32 v84, v84, s29, v246
    v_mfma_f32_32x32x16_bf16 v[160:175], a[92:95], v[204:207], v[160:175]
    v_exp_f32 v99, v99
    v_cvt_pk_bf16_f32 v73, v74, v75
    v_cvt_pk_bf16_f32 v89, v90, v91
    v_add_f32 v2, v2, v83
    v_fma_f32 v85, v85, s29, v246
    v_mfma_f32_32x32x16_bf16 v[128:143], a[96:99], v[208:211], v[128:143]
    v_exp_f32 v84, v84
    v_cvt_pk_bf16_f32 v74, v76, v77
    v_cvt_pk_bf16_f32 v90, v92, v93
    v_cvt_pk_bf16_f32 v75, v78, v79
    v_cvt_pk_bf16_f32 v91, v94, v95
    v_mfma_f32_32x32x16_bf16 v[144:159], a[100:103], v[208:211], v[144:159]
    v_add_f32 v2, v2, v98
    v_exp_f32 v85, v85
    v_fma_f32 v100, v100, s29, v246
    v_permlane16_swap_b32 v72, v88
    v_permlane16_swap_b32 v73, v89
    v_mfma_f32_32x32x16_bf16 v[160:175], a[104:107], v[208:211], v[160:175]
    v_permlane16_swap_b32 v74, v90
    v_permlane16_swap_b32 v75, v91
    v_add_f32 v2, v2, v99
    v_exp_f32 v100, v100
    v_fma_f32 v101, v101, s29, v246
    v_mfma_f32_32x32x16_bf16 v[128:143], a[108:111], v[212:215], v[128:143]
    v_add_f32 v2, v2, v84
    v_exp_f32 v101, v101
    v_fma_f32 v86, v86, s29, v246
    v_cvt_pk_bf16_f32 v76, v80, v81
    v_cvt_pk_bf16_f32 v77, v82, v83
    v_mfma_f32_32x32x16_bf16 v[144:159], a[112:115], v[212:215], v[144:159]
    v_add_f32 v2, v2, v85
    v_exp_f32 v86, v86
    v_fma_f32 v87, v87, s29, v246
    v_add_f32 v2, v2, v100
    v_add_f32 v2, v2, v101
    v_mfma_f32_32x32x16_bf16 v[160:175], a[116:119], v[212:215], v[160:175]
    v_exp_f32 v87, v87
    v_add_f32 v2, v2, v86
    v_cvt_pk_bf16_f32 v78, v84, v85
    v_add_f32 v2, v2, v87
    v_cvt_pk_bf16_f32 v79, v86, v87
    v_mfma_f32_32x32x16_bf16 v[128:143], a[120:123], v[216:219], v[128:143]
    v_fma_f32 v102, v102, s29, v246
    v_cvt_pk_bf16_f32 v92, v96, v97
    v_cvt_pk_bf16_f32 v93, v98, v99
    v_exp_f32 v102, v102
    v_fma_f32 v103, v103, s29, v246
    v_mfma_f32_32x32x16_bf16 v[144:159], a[124:127], v[216:219], v[144:159]
    v_exp_f32 v103, v103
    v_add_f32 v2, v2, v102
    v_cvt_pk_bf16_f32 v94, v100, v101
    v_add_f32 v2, v2, v103
    v_cvt_pk_bf16_f32 v95, v102, v103
    v_mfma_f32_32x32x16_bf16 v[160:175], a[128:131], v[216:219], v[160:175]
    ds_read_b128 v[200:203], v236 offset:24576
    v_permlane16_swap_b32 v76, v92
    v_permlane16_swap_b32 v77, v93
    v_permlane16_swap_b32 v78, v94
    v_permlane16_swap_b32 v79, v95
    s_waitcnt lgkmcnt(1)
    v_mfma_f32_32x32x16_bf16 v[128:143], a[132:135], v[220:223], v[128:143]
    ds_read_b128 v[204:207], v237 offset:24576
    ds_read_b128 v[208:211], v236 offset:25600
    ds_read_b128 v[212:215], v237 offset:25600
    ds_read_b128 v[216:219], v236 offset:26624
    v_mov_b32 v3, v2
    v_permlane32_swap_b32 v0, v1
    v_mfma_f32_32x32x16_bf16 v[144:159], a[136:139], v[220:223], v[144:159]
    v_permlane32_swap_b32 v2, v3
    v_add_f32 v0, v0, v1
    v_add_f32 v2, v2, v3
    v_rcp_f32 v0, v0
    ds_read_b128 v[60:63], v241 offset:33792
    v_mfma_f32_32x32x16_bf16 v[160:175], a[140:143], v[220:223], v[160:175]
    v_cvt_pk_bf16_f32 v128, v128, v129
    v_cvt_pk_bf16_f32 v129, v130, v131
    v_cvt_pk_bf16_f32 v131, v134, v135
    v_cvt_pk_bf16_f32 v134, v140, v141
    v_cvt_pk_bf16_f32 v135, v142, v143
    v_cvt_pk_bf16_f32 v130, v132, v133
    v_mfma_f32_16x16x32_bf16 v[80:83], v[176:179], v[72:75], 0
    v_cvt_pk_bf16_f32 v140, v152, v153
    v_cvt_pk_bf16_f32 v141, v154, v155
    v_mfma_f32_16x16x32_bf16 v[84:87], v[180:183], v[72:75], 0
    v_cvt_pk_bf16_f32 v142, v156, v157
    v_cvt_pk_bf16_f32 v143, v158, v159
    v_mfma_f32_16x16x32_bf16 v[40:43], v[184:187], v[72:75], 0
    v_cvt_pk_bf16_f32 v132, v136, v137
    v_cvt_pk_bf16_f32 v136, v144, v145
    v_mfma_f32_16x16x32_bf16 v[96:99], v[176:179], v[88:91], 0
    s_waitcnt lgkmcnt(0)
    v_cvt_pk_bf16_f32 v144, v160, v161
    v_mfma_f32_16x16x32_bf16 v[100:103], v[180:183], v[88:91], 0
    s_barrier
    v_mfma_f32_16x16x32_bf16 v[44:47], v[184:187], v[88:91], 0
    v_cvt_pk_bf16_f32 v145, v162, v163
    ds_read_b128 v[220:223], v237 offset:26624
    v_mfma_f32_16x16x32_bf16 v[80:83], v[188:191], v[76:79], v[80:83]
    v_cvt_pk_bf16_f32 v137, v146, v147
    v_cvt_pk_bf16_f32 v146, v164, v165
    v_mfma_f32_16x16x32_bf16 v[84:87], v[192:195], v[76:79], v[84:87]
    v_cvt_pk_bf16_f32 v147, v166, v167
    v_cvt_pk_bf16_f32 v133, v138, v139
    v_mfma_f32_16x16x32_bf16 v[40:43], v[196:199], v[76:79], v[40:43]
    v_cvt_pk_bf16_f32 v138, v148, v149
    v_cvt_pk_bf16_f32 v148, v168, v169
    v_mfma_f32_16x16x32_bf16 v[96:99], v[188:191], v[92:95], v[96:99]
    v_cvt_pk_bf16_f32 v149, v170, v171
    v_cvt_pk_bf16_f32 v139, v150, v151
    v_mfma_f32_16x16x32_bf16 v[100:103], v[192:195], v[92:95], v[100:103]
    v_cvt_pk_bf16_f32 v150, v172, v173
    v_cvt_pk_bf16_f32 v151, v174, v175
    v_mfma_f32_16x16x32_bf16 v[44:47], v[196:199], v[92:95], v[44:47]
    v_rcp_f32 v2, v2
    v_mfma_f32_16x16x32_bf16 v[152:155], v[200:203], a[144:147], 0
    v_mov_b32 v1, v0
    v_mov_b32 v3, v2
    v_mfma_f32_16x16x32_bf16 v[156:159], v[200:203], a[148:151], 0
    v_permlane16_swap_b32 v0, v1
    v_permlane16_swap_b32 v2, v3
    v_mfma_f32_16x16x32_bf16 v[160:163], v[200:203], a[152:155], 0
    ds_read_b128 v[200:203], v237 offset:30720
    v_mul_f32 v48, v48, v0
    v_mfma_f32_16x16x32_bf16 v[152:155], v[204:207], a[156:159], v[152:155]
    v_mul_f32 v49, v49, v0
    v_mul_f32 v64, v64, v1
    v_mfma_f32_16x16x32_bf16 v[156:159], v[204:207], a[160:163], v[156:159]
    v_mul_f32 v65, v65, v1
    v_mul_f32 v80, v80, v2
    v_mfma_f32_16x16x32_bf16 v[160:163], v[204:207], a[164:167], v[160:163]
    ds_read_b128 v[204:207], v236 offset:30720
    v_mul_f32 v81, v81, v2
    v_mfma_f32_16x16x32_bf16 v[152:155], v[208:211], a[168:171], v[152:155]
    v_mul_f32 v96, v96, v3
    v_mul_f32 v97, v97, v3
    v_mfma_f32_16x16x32_bf16 v[156:159], v[208:211], a[172:175], v[156:159]
    v_mul_f32 v50, v50, v0
    v_mul_f32 v51, v51, v0
    v_mfma_f32_16x16x32_bf16 v[160:163], v[208:211], a[176:179], v[160:163]
    ds_read_b128 v[208:211], v237 offset:31744
    v_cvt_pk_bf16_f32 v48, v48, v49
    v_mfma_f32_16x16x32_bf16 v[152:155], v[212:215], a[180:183], v[152:155]
    v_mul_f32 v224, v224, v0
    v_mul_f32 v225, v225, v0
    v_mfma_f32_16x16x32_bf16 v[156:159], v[212:215], a[184:187], v[156:159]
    v_mul_f32 v66, v66, v1
    v_mul_f32 v67, v67, v1
    v_mfma_f32_16x16x32_bf16 v[160:163], v[212:215], a[188:191], v[160:163]
    ds_read_b128 v[212:215], v236 offset:31744
    v_cvt_pk_bf16_f32 v64, v64, v65
    v_mfma_f32_16x16x32_bf16 v[152:155], v[216:219], a[192:195], v[152:155]
    v_mul_f32 v228, v228, v1
    v_mul_f32 v229, v229, v1
    v_mfma_f32_16x16x32_bf16 v[156:159], v[216:219], a[196:199], v[156:159]
    v_mul_f32 v82, v82, v2
    v_mul_f32 v83, v83, v2
    v_mfma_f32_16x16x32_bf16 v[160:163], v[216:219], a[200:203], v[160:163]
    ds_read_b128 v[216:219], v237 offset:32768
    s_waitcnt lgkmcnt(4)
    v_mfma_f32_16x16x32_bf16 v[152:155], v[220:223], a[204:207], v[152:155]
    v_cvt_pk_bf16_f32 v80, v80, v81
    v_mul_f32 v40, v40, v2
    v_mfma_f32_16x16x32_bf16 v[156:159], v[220:223], a[208:211], v[156:159]
    v_mul_f32 v41, v41, v2
    v_mul_f32 v98, v98, v3
    v_mfma_f32_16x16x32_bf16 v[160:163], v[220:223], a[212:215], v[160:163]
    ds_read_b128 v[220:223], v236 offset:32768
    v_mul_f32 v99, v99, v3
    v_mfma_f32_16x16x32_bf16 v[164:167], v[200:203], a[144:147], 0
    v_cvt_pk_bf16_f32 v176, v152, v153
    v_cvt_pk_bf16_f32 v177, v154, v155
    v_mfma_f32_16x16x32_bf16 v[168:171], v[200:203], a[148:151], 0
    v_cvt_pk_bf16_f32 v180, v156, v157
    v_cvt_pk_bf16_f32 v181, v158, v159
    v_mfma_f32_16x16x32_bf16 v[172:175], v[200:203], a[152:155], 0
    ds_read_b128 v[200:203], v236 offset:36864
    s_waitcnt lgkmcnt(4)
    v_mfma_f32_16x16x32_bf16 v[164:167], v[204:207], a[156:159], v[164:167]
    v_cvt_pk_bf16_f32 v184, v160, v161
    v_cvt_pk_bf16_f32 v185, v162, v163
    v_mfma_f32_16x16x32_bf16 v[168:171], v[204:207], a[160:163], v[168:171]
    v_cvt_pk_bf16_f32 v96, v96, v97
    v_mul_f32 v44, v44, v3
    v_mfma_f32_16x16x32_bf16 v[172:175], v[204:207], a[164:167], v[172:175]
    ds_read_b128 v[204:207], v237 offset:36864
    v_mul_f32 v45, v45, v3
    v_mfma_f32_16x16x32_bf16 v[164:167], v[208:211], a[168:171], v[164:167]
    v_cvt_pk_bf16_f32 v49, v50, v51
    v_mul_f32 v52, v52, v0
    v_mfma_f32_16x16x32_bf16 v[168:171], v[208:211], a[172:175], v[168:171]
    v_mul_f32 v53, v53, v0
    v_mul_f32 v54, v54, v0
    v_mfma_f32_16x16x32_bf16 v[172:175], v[208:211], a[176:179], v[172:175]
    ds_read_b128 v[208:211], v236 offset:37888
    s_waitcnt lgkmcnt(4)
    v_mfma_f32_16x16x32_bf16 v[164:167], v[212:215], a[180:183], v[164:167]
    v_mul_f32 v55, v55, v0
    v_mul_f32 v226, v226, v0
    v_mfma_f32_16x16x32_bf16 v[168:171], v[212:215], a[184:187], v[168:171]
    v_mul_f32 v227, v227, v0
    v_cvt_pk_bf16_f32 v224, v224, v225
    v_mfma_f32_16x16x32_bf16 v[172:175], v[212:215], a[188:191], v[172:175]
    ds_read_b128 v[212:215], v237 offset:37888
    v_cvt_pk_bf16_f32 v65, v66, v67
    v_mfma_f32_16x16x32_bf16 v[164:167], v[216:219], a[192:195], v[164:167]
    v_mul_f32 v68, v68, v1
    v_mul_f32 v69, v69, v1
    v_mfma_f32_16x16x32_bf16 v[168:171], v[216:219], a[196:199], v[168:171]
    v_mul_f32 v70, v70, v1
    v_mul_f32 v71, v71, v1
    v_mfma_f32_16x16x32_bf16 v[172:175], v[216:219], a[200:203], v[172:175]
    ds_read_b128 v[216:219], v236 offset:38912
    s_waitcnt lgkmcnt(4)
    v_mfma_f32_16x16x32_bf16 v[164:167], v[220:223], a[204:207], v[164:167]
    v_mul_f32 v230, v230, v1
    v_mul_f32 v231, v231, v1
    v_mfma_f32_16x16x32_bf16 v[168:171], v[220:223], a[208:211], v[168:171]
    v_cvt_pk_bf16_f32 v228, v228, v229
    v_cvt_pk_bf16_f32 v81, v82, v83
    v_mfma_f32_16x16x32_bf16 v[172:175], v[220:223], a[212:215], v[172:175]
    ds_read_b128 v[220:223], v237 offset:38912
    v_mul_f32 v84, v84, v2
    v_mfma_f32_16x16x32_bf16 v[152:155], v[200:203], a[144:147], 0
    v_cvt_pk_bf16_f32 v178, v164, v165
    v_cvt_pk_bf16_f32 v179, v166, v167
    v_mfma_f32_16x16x32_bf16 v[156:159], v[200:203], a[148:151], 0
    v_cvt_pk_bf16_f32 v182, v168, v169
    v_cvt_pk_bf16_f32 v183, v170, v171
    v_mfma_f32_16x16x32_bf16 v[160:163], v[200:203], a[152:155], 0
    ds_read_b128 v[200:203], v237 offset:43008
    s_waitcnt lgkmcnt(4)
    v_mfma_f32_16x16x32_bf16 v[152:155], v[204:207], a[156:159], v[152:155]
    v_mul_f32 v85, v85, v2
    v_mul_f32 v86, v86, v2
    v_mfma_f32_16x16x32_bf16 v[156:159], v[204:207], a[160:163], v[156:159]
    v_mul_f32 v87, v87, v2
    v_mul_f32 v42, v42, v2
    v_mfma_f32_16x16x32_bf16 v[160:163], v[204:207], a[164:167], v[160:163]
    ds_read_b128 v[204:207], v236 offset:43008
    v_mul_f32 v43, v43, v2
    v_mfma_f32_16x16x32_bf16 v[152:155], v[208:211], a[168:171], v[152:155]
    v_cvt_pk_bf16_f32 v40, v40, v41
    v_cvt_pk_bf16_f32 v97, v98, v99
    v_mfma_f32_16x16x32_bf16 v[156:159], v[208:211], a[172:175], v[156:159]
    v_mul_f32 v100, v100, v3
    v_mul_f32 v101, v101, v3
    v_mfma_f32_16x16x32_bf16 v[160:163], v[208:211], a[176:179], v[160:163]
    ds_read_b128 v[208:211], v237 offset:44032
    s_waitcnt lgkmcnt(4)
    v_mfma_f32_16x16x32_bf16 v[152:155], v[212:215], a[180:183], v[152:155]
    v_mul_f32 v102, v102, v3
    v_mul_f32 v103, v103, v3
    v_mfma_f32_16x16x32_bf16 v[156:159], v[212:215], a[184:187], v[156:159]
    v_mul_f32 v46, v46, v3
    v_mul_f32 v47, v47, v3
    v_mfma_f32_16x16x32_bf16 v[160:163], v[212:215], a[188:191], v[160:163]
    ds_read_b128 v[212:215], v236 offset:44032
    v_cvt_pk_bf16_f32 v44, v44, v45
    v_mfma_f32_16x16x32_bf16 v[152:155], v[216:219], a[192:195], v[152:155]
    v_cvt_pk_bf16_f32 v186, v172, v173
    v_cvt_pk_bf16_f32 v187, v174, v175
    v_mfma_f32_16x16x32_bf16 v[156:159], v[216:219], a[196:199], v[156:159]
    v_cvt_pk_bf16_f32 v50, v52, v53
    v_cvt_pk_bf16_f32 v51, v54, v55
    v_mfma_f32_16x16x32_bf16 v[160:163], v[216:219], a[200:203], v[160:163]
    v_cvt_pk_bf16_f32 v225, v226, v227
    s_waitcnt lgkmcnt(3)
    v_mfma_f32_16x16x32_bf16 v[152:155], v[220:223], a[204:207], v[152:155]
    v_cvt_pk_bf16_f32 v66, v68, v69
    v_cvt_pk_bf16_f32 v67, v70, v71
    v_mfma_f32_16x16x32_bf16 v[156:159], v[220:223], a[208:211], v[156:159]
    v_cvt_pk_bf16_f32 v229, v230, v231
    v_cvt_pk_bf16_f32 v82, v84, v85
    v_mfma_f32_16x16x32_bf16 v[160:163], v[220:223], a[212:215], v[160:163]
    v_cvt_pk_bf16_f32 v83, v86, v87
    v_cvt_pk_bf16_f32 v41, v42, v43
    v_mfma_f32_16x16x32_bf16 v[164:167], v[200:203], a[144:147], 0
    v_cvt_pk_bf16_f32 v98, v100, v101
    v_cvt_pk_bf16_f32 v99, v102, v103
    v_mfma_f32_16x16x32_bf16 v[168:171], v[200:203], a[148:151], 0
    v_cvt_pk_bf16_f32 v45, v46, v47
    ds_read_b128 v[216:219], v237 offset:45056
    v_mfma_f32_16x16x32_bf16 v[172:175], v[200:203], a[152:155], 0
    ds_read_b128 v[220:223], v236 offset:45056
    s_waitcnt lgkmcnt(3)
    v_mfma_f32_16x16x32_bf16 v[164:167], v[204:207], a[156:159], v[164:167]
    ds_write_b128 v239, v[48:51] offset:0
    v_mfma_f32_16x16x32_bf16 v[168:171], v[204:207], a[160:163], v[168:171]
    v_cvt_pk_bf16_f32 v188, v152, v153
    v_cvt_pk_bf16_f32 v189, v154, v155
    v_mfma_f32_16x16x32_bf16 v[172:175], v[204:207], a[164:167], v[172:175]
    v_cvt_pk_bf16_f32 v192, v156, v157
    v_cvt_pk_bf16_f32 v193, v158, v159
    ds_write_b64 v240, v[224:225] offset:0
    v_mfma_f32_16x16x32_bf16 v[164:167], v[208:211], a[168:171], v[164:167]
    v_cvt_pk_bf16_f32 v196, v160, v161
    v_cvt_pk_bf16_f32 v197, v162, v163
    v_mfma_f32_16x16x32_bf16 v[168:171], v[208:211], a[172:175], v[168:171]
    ds_read_b128 v[68:71], v241 offset:35840
    ds_read_b128 v[72:75], v241 offset:36864
    ds_write_b128 v239, v[64:67] offset:6144
    v_mfma_f32_16x16x32_bf16 v[172:175], v[208:211], a[176:179], v[172:175]
    ds_read_b128 v[64:67], v241 offset:34816
    s_waitcnt lgkmcnt(8)
    v_mfma_f32_16x16x32_bf16 v[164:167], v[212:215], a[180:183], v[164:167]
    ds_read_b128 v[76:79], v241 offset:37888
    ds_read_b128 v[88:91], v241 offset:38912
    ds_write_b64 v240, v[228:229] offset:6144
    v_mfma_f32_16x16x32_bf16 v[168:171], v[212:215], a[184:187], v[168:171]
    ds_read_b128 v[92:95], v241 offset:39936
    v_mfma_f32_16x16x32_bf16 v[172:175], v[212:215], a[188:191], v[172:175]
    s_waitcnt lgkmcnt(10)
    v_mfma_f32_16x16x32_bf16 v[164:167], v[216:219], a[192:195], v[164:167]
    ds_write_b128 v239, v[80:83] offset:12288
    v_mfma_f32_16x16x32_bf16 v[168:171], v[216:219], a[196:199], v[168:171]
    v_mfma_f32_16x16x32_bf16 v[172:175], v[216:219], a[200:203], v[172:175]
    v_mfma_f32_16x16x32_bf16 v[164:167], v[220:223], a[204:207], v[164:167]
    ds_write_b64 v240, v[40:41] offset:12288
    v_mfma_f32_16x16x32_bf16 v[168:171], v[220:223], a[208:211], v[168:171]
    v_mfma_f32_16x16x32_bf16 v[172:175], v[220:223], a[212:215], v[172:175]
    ds_write_b128 v239, v[96:99] offset:18432
    ds_write_b64 v240, v[44:45] offset:18432
    s_nop 2
    v_cvt_pk_bf16_f32 v190, v164, v165
    v_cvt_pk_bf16_f32 v191, v166, v167
    v_cvt_pk_bf16_f32 v194, v168, v169
    v_cvt_pk_bf16_f32 v195, v170, v171
    v_cvt_pk_bf16_f32 v198, v172, v173
    v_cvt_pk_bf16_f32 v199, v174, v175
    s_waitcnt vmcnt(0) lgkmcnt(0)
    s_barrier
    ds_read_b128 v[200:203], v238 offset:0
    ds_read_b128 v[204:207], v238 offset:1024
    ds_read_b128 v[208:211], v238 offset:4096
    ds_read_b128 v[212:215], v238 offset:2048
    ds_read_b128 v[216:219], v238 offset:3072
    ds_read_b128 v[220:223], v238 offset:5120
    s_waitcnt lgkmcnt(5)
    v_mfma_f32_16x16x32_bf16 v[152:155], a[216:219], v[200:203], 0
    v_mfma_f32_16x16x32_bf16 v[156:159], a[220:223], v[200:203], 0
    v_mfma_f32_16x16x32_bf16 v[160:163], a[224:227], v[200:203], 0
    ds_read_b128 v[200:203], v238 offset:12288
    s_waitcnt lgkmcnt(5)
    v_mfma_f32_16x16x32_bf16 v[152:155], a[228:231], v[204:207], v[152:155]
    v_mfma_f32_16x16x32_bf16 v[156:159], a[232:235], v[204:207], v[156:159]
    v_mfma_f32_16x16x32_bf16 v[160:163], a[236:239], v[204:207], v[160:163]
    ds_read_b128 v[204:207], v238 offset:13312
    s_waitcnt lgkmcnt(2)
    v_mfma_f32_16x16x32_bf16 v[152:155], a[240:243], v[208:211], v[152:155]
    v_mfma_f32_16x16x32_bf16 v[156:159], a[244:247], v[208:211], v[156:159]
    v_mfma_f32_16x16x32_bf16 v[160:163], a[248:251], v[208:211], v[160:163]
    ds_read_b128 v[208:211], v238 offset:16384
    v_mfma_f32_16x16x32_bf16 v[152:155], a[252:255], v[212:215], v[152:155]
    v_mfma_f32_16x16x32_bf16 v[156:159], v[56:59], v[212:215], v[156:159]
    v_mfma_f32_16x16x32_bf16 v[160:163], v[60:63], v[212:215], v[160:163]
    ds_read_b128 v[212:215], v238 offset:14336
    v_mfma_f32_16x16x32_bf16 v[152:155], v[64:67], v[216:219], v[152:155]
    v_mfma_f32_16x16x32_bf16 v[156:159], v[68:71], v[216:219], v[156:159]
    v_mfma_f32_16x16x32_bf16 v[160:163], v[72:75], v[216:219], v[160:163]
    ds_read_b128 v[216:219], v238 offset:15360
    v_mfma_f32_16x16x32_bf16 v[152:155], v[76:79], v[220:223], v[152:155]
    v_mfma_f32_16x16x32_bf16 v[156:159], v[88:91], v[220:223], v[156:159]
    v_mfma_f32_16x16x32_bf16 v[160:163], v[92:95], v[220:223], v[160:163]
    ds_read_b128 v[220:223], v238 offset:17408
    s_waitcnt lgkmcnt(4)
    v_mfma_f32_16x16x32_bf16 v[164:167], a[216:219], v[200:203], 0
    v_mfma_f32_16x16x32_bf16 v[168:171], a[220:223], v[200:203], 0
    v_mfma_f32_16x16x32_bf16 v[172:175], a[224:227], v[200:203], 0
    ds_read_b128 v[200:203], v238 offset:6144
    v_cvt_pk_bf16_f32 v152, v152, v153
    v_mfma_f32_16x16x32_bf16 v[164:167], a[228:231], v[204:207], v[164:167]
    v_cvt_pk_bf16_f32 v153, v154, v155
    v_cvt_pk_bf16_f32 v154, v156, v157
    v_mfma_f32_16x16x32_bf16 v[168:171], a[232:235], v[204:207], v[168:171]
    v_cvt_pk_bf16_f32 v155, v158, v159
    v_cvt_pk_bf16_f32 v160, v160, v161
    v_mfma_f32_16x16x32_bf16 v[172:175], a[236:239], v[204:207], v[172:175]
    ds_read_b128 v[204:207], v238 offset:7168
    s_waitcnt lgkmcnt(4)
    v_mfma_f32_16x16x32_bf16 v[164:167], a[240:243], v[208:211], v[164:167]
    ds_write_b128 v247, v[152:155] offset:0
    v_mfma_f32_16x16x32_bf16 v[168:171], a[244:247], v[208:211], v[168:171]
    v_cvt_pk_bf16_f32 v161, v162, v163
    v_mfma_f32_16x16x32_bf16 v[172:175], a[248:251], v[208:211], v[172:175]
    ds_read_b128 v[208:211], v238 offset:10240
    v_mfma_f32_16x16x32_bf16 v[164:167], a[252:255], v[212:215], v[164:167]
    ds_write_b64 v248, v[160:161] offset:0
    v_mfma_f32_16x16x32_bf16 v[168:171], v[56:59], v[212:215], v[168:171]
    v_mfma_f32_16x16x32_bf16 v[172:175], v[60:63], v[212:215], v[172:175]
    ds_read_b128 v[212:215], v238 offset:8192
    s_waitcnt lgkmcnt(6)
    v_mfma_f32_16x16x32_bf16 v[164:167], v[64:67], v[216:219], v[164:167]
    v_mfma_f32_16x16x32_bf16 v[168:171], v[68:71], v[216:219], v[168:171]
    v_mfma_f32_16x16x32_bf16 v[172:175], v[72:75], v[216:219], v[172:175]
    ds_read_b128 v[216:219], v238 offset:9216
    v_mfma_f32_16x16x32_bf16 v[164:167], v[76:79], v[220:223], v[164:167]
    v_mfma_f32_16x16x32_bf16 v[168:171], v[88:91], v[220:223], v[168:171]
    v_mfma_f32_16x16x32_bf16 v[172:175], v[92:95], v[220:223], v[172:175]
    ds_read_b128 v[220:223], v238 offset:11264
    s_waitcnt lgkmcnt(5)
    v_mfma_f32_16x16x32_bf16 v[152:155], a[216:219], v[200:203], 0
    v_mfma_f32_16x16x32_bf16 v[156:159], a[220:223], v[200:203], 0
    v_mfma_f32_16x16x32_bf16 v[160:163], a[224:227], v[200:203], 0
    ds_read_b128 v[200:203], v238 offset:18432
    v_cvt_pk_bf16_f32 v164, v164, v165
    v_mfma_f32_16x16x32_bf16 v[152:155], a[228:231], v[204:207], v[152:155]
    v_cvt_pk_bf16_f32 v165, v166, v167
    v_cvt_pk_bf16_f32 v166, v168, v169
    v_mfma_f32_16x16x32_bf16 v[156:159], a[232:235], v[204:207], v[156:159]
    v_cvt_pk_bf16_f32 v167, v170, v171
    v_cvt_pk_bf16_f32 v172, v172, v173
    v_mfma_f32_16x16x32_bf16 v[160:163], a[236:239], v[204:207], v[160:163]
    ds_read_b128 v[204:207], v238 offset:19456
    s_waitcnt lgkmcnt(4)
    v_mfma_f32_16x16x32_bf16 v[152:155], a[240:243], v[208:211], v[152:155]
    ds_write_b128 v247, v[164:167] offset:768
    v_mfma_f32_16x16x32_bf16 v[156:159], a[244:247], v[208:211], v[156:159]
    v_cvt_pk_bf16_f32 v173, v174, v175
    v_mfma_f32_16x16x32_bf16 v[160:163], a[248:251], v[208:211], v[160:163]
    ds_read_b128 v[208:211], v238 offset:22528
    v_mfma_f32_16x16x32_bf16 v[152:155], a[252:255], v[212:215], v[152:155]
    ds_write_b64 v248, v[172:173] offset:768
    v_mfma_f32_16x16x32_bf16 v[156:159], v[56:59], v[212:215], v[156:159]
    ds_read_b128 v[40:43], v241 offset:0
    ds_read_b128 v[44:47], v241 offset:1024
    v_mfma_f32_16x16x32_bf16 v[160:163], v[60:63], v[212:215], v[160:163]
    ds_read_b128 v[212:215], v238 offset:20480
    s_waitcnt lgkmcnt(8)
    v_mfma_f32_16x16x32_bf16 v[152:155], v[64:67], v[216:219], v[152:155]
    ds_read_b128 v[48:51], v241 offset:2048
    v_mfma_f32_16x16x32_bf16 v[156:159], v[68:71], v[216:219], v[156:159]
    v_mfma_f32_16x16x32_bf16 v[160:163], v[72:75], v[216:219], v[160:163]
    ds_read_b128 v[216:219], v238 offset:21504
    v_mfma_f32_16x16x32_bf16 v[152:155], v[76:79], v[220:223], v[152:155]
    v_mfma_f32_16x16x32_bf16 v[156:159], v[88:91], v[220:223], v[156:159]
    v_mfma_f32_16x16x32_bf16 v[160:163], v[92:95], v[220:223], v[160:163]
    ds_read_b128 v[220:223], v238 offset:23552
    s_waitcnt lgkmcnt(8)
    v_mfma_f32_16x16x32_bf16 v[164:167], a[216:219], v[200:203], 0
    v_mfma_f32_16x16x32_bf16 v[168:171], a[220:223], v[200:203], 0
    v_mfma_f32_16x16x32_bf16 v[172:175], a[224:227], v[200:203], 0
    v_mfma_f32_16x16x32_bf16 v[164:167], a[228:231], v[204:207], v[164:167]
    v_cvt_pk_bf16_f32 v152, v152, v153
    v_cvt_pk_bf16_f32 v153, v154, v155
    v_mfma_f32_16x16x32_bf16 v[168:171], a[232:235], v[204:207], v[168:171]
    v_cvt_pk_bf16_f32 v154, v156, v157
    v_cvt_pk_bf16_f32 v155, v158, v159
    v_mfma_f32_16x16x32_bf16 v[172:175], a[236:239], v[204:207], v[172:175]
    v_cvt_pk_bf16_f32 v160, v160, v161
    s_waitcnt lgkmcnt(2)
    v_mfma_f32_16x16x32_bf16 v[164:167], a[240:243], v[208:211], v[164:167]
    ds_write_b128 v247, v[152:155] offset:3072
    v_mfma_f32_16x16x32_bf16 v[168:171], a[244:247], v[208:211], v[168:171]
    v_cvt_pk_bf16_f32 v161, v162, v163
    v_mfma_f32_16x16x32_bf16 v[172:175], a[248:251], v[208:211], v[172:175]
    buffer_store_dwordx4 v[40:43], v249, s[12:15], s32 offen nt
    v_mfma_f32_16x16x32_bf16 v[164:167], a[252:255], v[212:215], v[164:167]
    ds_write_b64 v248, v[160:161] offset:3072
    v_mfma_f32_16x16x32_bf16 v[168:171], v[56:59], v[212:215], v[168:171]
    v_mfma_f32_16x16x32_bf16 v[172:175], v[60:63], v[212:215], v[172:175]
    s_waitcnt lgkmcnt(2)
    v_mfma_f32_16x16x32_bf16 v[164:167], v[64:67], v[216:219], v[164:167]
    buffer_store_dwordx4 v[44:47], v250, s[12:15], s32 offen nt
    v_mfma_f32_16x16x32_bf16 v[168:171], v[68:71], v[216:219], v[168:171]
    v_mfma_f32_16x16x32_bf16 v[172:175], v[72:75], v[216:219], v[172:175]
    v_mfma_f32_16x16x32_bf16 v[164:167], v[76:79], v[220:223], v[164:167]
    buffer_store_dwordx4 v[48:51], v251, s[12:15], s32 offen nt
    v_mfma_f32_16x16x32_bf16 v[168:171], v[88:91], v[220:223], v[168:171]
    v_mfma_f32_16x16x32_bf16 v[172:175], v[92:95], v[220:223], v[172:175]
    s_waitcnt lgkmcnt(0)
    s_nop 7
    s_nop 3
.p2align 5
LOOP:
    v_mfma_f32_32x32x16_bf16 v[40:55], v[116:119], v[104:107], v[4:19]
    ds_read_b128 v[200:203], v232 offset:0
    ds_read_b128 v[204:207], v233 offset:0
    v_cvt_pk_bf16_f32 v164, v164, v165
    v_cvt_pk_bf16_f32 v165, v166, v167
    v_cvt_pk_bf16_f32 v166, v168, v169
    v_cvt_pk_bf16_f32 v167, v170, v171
    v_mfma_f32_32x32x16_bf16 v[56:71], v[140:143], v[104:107], v[24:39]
    v_cvt_pk_bf16_f32 v172, v172, v173
    ds_write_b128 v247, v[164:167] offset:3840
    v_cvt_pk_bf16_f32 v173, v174, v175
    ds_read_b128 v[208:211], v234 offset:0
    ds_read_b128 v[212:215], v235 offset:0
    v_mfma_f32_32x32x16_bf16 v[40:55], v[120:123], v[108:111], v[40:55]
    ds_read_b128 v[216:219], v232 offset:1024
    ds_read_b128 v[220:223], v233 offset:1024
    v_readlane_b32 s40, v244, 49
    ds_write_b64 v248, v[172:173] offset:3840
    ds_read_b128 v[152:155], v241 offset:3072
    v_mfma_f32_32x32x16_bf16 v[56:71], v[144:147], v[108:111], v[56:71]
    ds_read_b128 v[156:159], v241 offset:4096
    ds_read_b128 v[160:163], v241 offset:5120
    v_mov_b32 v245, s40
    v_readlane_b32 s38, v244, 35
    v_cndmask_b32 v245, 0, v245, s[42:43]
    v_readlane_b32 s36, v244, 3
    v_mfma_f32_32x32x16_bf16 v[40:55], v[124:127], v[112:115], v[40:55]
    v_mad_i32_i24 v242, v243, s38, v242
    s_add_u32 m0, s31, 24576
    v_readlane_b32 s37, v244, 19
    v_readlane_b32 s39, v244, 33
    v_readlane_b32 s32, v244, 1
    v_mfma_f32_32x32x16_bf16 v[56:71], v[148:151], v[112:115], v[56:71]
    buffer_load_dwordx4 v242, s[8:11], s36 offen offset:0 lds
    s_add_u32 m0, s31, 25472
    v_mfma_f32_32x32x16_bf16 v[72:87], v[116:119], v[128:131], v[20:35]
    v_mfma_f32_32x32x16_bf16 v[88:103], v[140:143], v[128:131], v[4:19]
    v_mfma_f32_32x32x16_bf16 v[72:87], v[120:123], v[132:135], v[72:87]
    s_waitcnt lgkmcnt(1)
    buffer_store_dwordx4 v[152:155], v249, s[12:15], s33 offen nt
    v_max3_f32 v246, v40, v41, v42
    v_max3_f32 v246, v246, v43, v44
    v_max3_f32 v246, v246, v45, v46
    v_mfma_f32_32x32x16_bf16 v[88:103], v[144:147], v[132:135], v[88:103]
    v_max3_f32 v246, v246, v47, v48
    v_max3_f32 v246, v246, v49, v50
    v_max3_f32 v246, v246, v51, v52
    v_max3_f32 v246, v246, v53, v54
    v_max3_f32 v246, v246, v55, v56
    v_max3_f32 v246, v246, v57, v58
    v_mfma_f32_32x32x16_bf16 v[72:87], v[124:127], v[136:139], v[72:87]
    v_max3_f32 v246, v246, v59, v60
    v_max3_f32 v246, v246, v61, v62
    v_max3_f32 v246, v246, v63, v64
    v_max3_f32 v246, v246, v65, v66
    v_max3_f32 v246, v246, v67, v68
    v_max3_f32 v246, v246, v69, v70
    v_mfma_f32_32x32x16_bf16 v[88:103], v[148:151], v[136:139], v[88:103]
    buffer_store_dwordx4 v[156:159], v250, s[12:15], s33 offen nt
    v_max_f32 v246, v246, v71
    v_fma_f32 v246, v246, s29, v245
    v_mov_b32 v1, v246
    v_mad_i32_i24 v249, v252, s39, v249
    v_mfma_f32_32x32x16_bf16 v[104:119], a[0:3], v[200:203], 0
    v_permlane32_swap_b32 v246, v1
    v_max_f32 v246, v246, v1
    v_sub_f32 v246, v245, v246
    v_fma_f32 v40, v40, s29, v246
    v_fma_f32 v41, v41, s29, v246
    v_fma_f32 v56, v56, s29, v246
    v_mfma_f32_32x32x16_bf16 v[120:135], a[4:7], v[200:203], 0
    v_exp_f32 v40, v40
    v_exp_f32 v41, v41
    v_exp_f32 v56, v56
    v_mfma_f32_32x32x16_bf16 v[136:151], a[8:11], v[200:203], 0
    s_waitcnt lgkmcnt(0)
    buffer_store_dwordx4 v[160:163], v251, s[12:15], s33 offen nt
    ds_read_b128 v[200:203], v234 offset:1024
    v_fma_f32 v57, v57, s29, v246
    v_fma_f32 v42, v42, s29, v246
    v_mfma_f32_32x32x16_bf16 v[104:119], a[12:15], v[204:207], v[104:119]
    v_exp_f32 v57, v57
    v_add_f32 v0, v40, v41
    v_exp_f32 v42, v42
    v_fma_f32 v43, v43, s29, v246
    v_mfma_f32_32x32x16_bf16 v[120:135], a[16:19], v[204:207], v[120:135]
    v_add_f32 v0, v0, v56
    v_exp_f32 v43, v43
    v_fma_f32 v58, v58, s29, v246
    v_add_f32 v0, v0, v57
    v_fma_f32 v59, v59, s29, v246
    v_mfma_f32_32x32x16_bf16 v[136:151], a[20:23], v[204:207], v[136:151]
    ds_read_b128 v[204:207], v235 offset:1024
    buffer_load_dwordx4 v242, s[8:11], s36 offen offset:128 lds
    s_add_u32 m0, s31, 26368
    v_mfma_f32_32x32x16_bf16 v[104:119], a[24:27], v[208:211], v[104:119]
    v_exp_f32 v58, v58
    v_add_f32 v0, v0, v42
    v_exp_f32 v59, v59
    v_fma_f32 v44, v44, s29, v246
    v_mfma_f32_32x32x16_bf16 v[120:135], a[28:31], v[208:211], v[120:135]
    v_add_f32 v0, v0, v43
    v_exp_f32 v44, v44
    v_fma_f32 v45, v45, s29, v246
    v_add_f32 v0, v0, v58
    v_fma_f32 v60, v60, s29, v246
    v_mfma_f32_32x32x16_bf16 v[136:151], a[32:35], v[208:211], v[136:151]
    ds_read_b128 v[208:211], v232 offset:2048
    buffer_load_dwordx4 v242, s[8:11], s36 offen offset:256 lds
    s_add_u32 m0, s31, 36864
    v_mfma_f32_32x32x16_bf16 v[104:119], a[36:39], v[212:215], v[104:119]
    v_exp_f32 v45, v45
    v_add_f32 v0, v0, v59
    v_exp_f32 v60, v60
    v_fma_f32 v61, v61, s29, v246
    v_mfma_f32_32x32x16_bf16 v[120:135], a[40:43], v[212:215], v[120:135]
    v_add_f32 v0, v0, v44
    v_exp_f32 v61, v61
    v_fma_f32 v46, v46, s29, v246
    v_add_f32 v0, v0, v45
    v_fma_f32 v47, v47, s29, v246
    v_mfma_f32_32x32x16_bf16 v[136:151], a[44:47], v[212:215], v[136:151]
    ds_read_b128 v[212:215], v233 offset:2048
    buffer_load_dwordx4 v242, s[8:11], s37 offen offset:0 lds
    v_add_f32 v0, v0, v60
    v_mfma_f32_32x32x16_bf16 v[104:119], a[48:51], v[216:219], v[104:119]
    v_exp_f32 v46, v46
    v_exp_f32 v47, v47
    v_fma_f32 v62, v62, s29, v246
    s_add_u32 m0, s31, 37760
    v_mfma_f32_32x32x16_bf16 v[120:135], a[52:55], v[216:219], v[120:135]
    v_add_f32 v0, v0, v61
    v_exp_f32 v62, v62
    v_fma_f32 v63, v63, s29, v246
    v_add_f32 v0, v0, v46
    v_fma_f32 v48, v48, s29, v246
    v_mfma_f32_32x32x16_bf16 v[136:151], a[56:59], v[216:219], v[136:151]
    ds_read_b128 v[216:219], v234 offset:2048
    buffer_load_dwordx4 v242, s[8:11], s37 offen offset:128 lds
    v_add_f32 v0, v0, v47
    v_mfma_f32_32x32x16_bf16 v[104:119], a[60:63], v[220:223], v[104:119]
    v_exp_f32 v63, v63
    v_exp_f32 v48, v48
    v_fma_f32 v49, v49, s29, v246
    v_add_f32 v0, v0, v62
    v_mfma_f32_32x32x16_bf16 v[120:135], a[64:67], v[220:223], v[120:135]
    v_exp_f32 v49, v49
    v_fma_f32 v64, v64, s29, v246
    v_add_f32 v0, v0, v63
    v_exp_f32 v64, v64
    v_mfma_f32_32x32x16_bf16 v[136:151], a[68:71], v[220:223], v[136:151]
    ds_read_b128 v[220:223], v235 offset:2048
    v_fma_f32 v65, v65, s29, v246
    s_add_u32 m0, s31, 38656
    v_add_f32 v0, v0, v48
    v_fma_f32 v50, v50, s29, v246
    s_waitcnt lgkmcnt(2)
    v_mfma_f32_32x32x16_bf16 v[104:119], a[72:75], v[200:203], v[104:119]
    v_exp_f32 v65, v65
    buffer_load_dwordx4 v242, s[8:11], s37 offen offset:256 lds
    v_mfma_f32_32x32x16_bf16 v[120:135], a[76:79], v[200:203], v[120:135]
    v_add_f32 v0, v0, v49
    v_exp_f32 v50, v50
    v_fma_f32 v51, v51, s29, v246
    v_add_f32 v0, v0, v64
    v_fma_f32 v66, v66, s29, v246
    v_mfma_f32_32x32x16_bf16 v[136:151], a[80:83], v[200:203], v[136:151]
    v_exp_f32 v51, v51
    v_add_f32 v0, v0, v65
    v_exp_f32 v66, v66
    v_fma_f32 v67, v67, s29, v246
    v_mfma_f32_32x32x16_bf16 v[104:119], a[84:87], v[204:207], v[104:119]
    v_cvt_pk_bf16_f32 v40, v40, v41
    v_cvt_pk_bf16_f32 v56, v56, v57
    v_add_f32 v0, v0, v50
    v_exp_f32 v67, v67
    v_fma_f32 v52, v52, s29, v246
    v_mfma_f32_32x32x16_bf16 v[120:135], a[88:91], v[204:207], v[120:135]
    v_cvt_pk_bf16_f32 v41, v42, v43
    v_cvt_pk_bf16_f32 v57, v58, v59
    v_add_f32 v0, v0, v51
    v_exp_f32 v52, v52
    v_fma_f32 v53, v53, s29, v246
    v_mfma_f32_32x32x16_bf16 v[136:151], a[92:95], v[204:207], v[136:151]
    v_cvt_pk_bf16_f32 v42, v44, v45
    v_cvt_pk_bf16_f32 v58, v60, v61
    v_cvt_pk_bf16_f32 v43, v46, v47
    v_cvt_pk_bf16_f32 v59, v62, v63
    v_add_f32 v0, v0, v66
    v_fma_f32 v68, v68, s29, v246
    v_mfma_f32_32x32x16_bf16 v[104:119], a[96:99], v[208:211], v[104:119]
    v_exp_f32 v53, v53
    v_permlane16_swap_b32 v40, v56
    v_permlane16_swap_b32 v41, v57
    v_permlane16_swap_b32 v42, v58
    v_permlane16_swap_b32 v43, v59
    v_mfma_f32_32x32x16_bf16 v[120:135], a[100:103], v[208:211], v[120:135]
    v_add_f32 v0, v0, v67
    v_exp_f32 v68, v68
    v_fma_f32 v69, v69, s29, v246
    v_add_f32 v0, v0, v52
    v_fma_f32 v54, v54, s29, v246
    v_mfma_f32_32x32x16_bf16 v[136:151], a[104:107], v[208:211], v[136:151]
    v_exp_f32 v69, v69
    v_cvt_pk_bf16_f32 v44, v48, v49
    v_cvt_pk_bf16_f32 v45, v50, v51
    v_add_f32 v0, v0, v53
    v_fma_f32 v55, v55, s29, v246
    v_mfma_f32_32x32x16_bf16 v[104:119], a[108:111], v[212:215], v[104:119]
    v_exp_f32 v54, v54
    v_add_f32 v0, v0, v68
    v_exp_f32 v55, v55
    v_add_f32 v0, v0, v69
    v_mfma_f32_32x32x16_bf16 v[120:135], a[112:115], v[212:215], v[120:135]
    v_add_f32 v0, v0, v54
    v_cvt_pk_bf16_f32 v46, v52, v53
    v_add_f32 v0, v0, v55
    v_cvt_pk_bf16_f32 v47, v54, v55
    v_fma_f32 v70, v70, s29, v246
    v_cvt_pk_bf16_f32 v60, v64, v65
    v_mfma_f32_32x32x16_bf16 v[136:151], a[116:119], v[212:215], v[136:151]
    v_cvt_pk_bf16_f32 v61, v66, v67
    v_exp_f32 v70, v70
    v_fma_f32 v71, v71, s29, v246
    v_add_f32 v0, v0, v70
    s_waitcnt lgkmcnt(0)
    v_mfma_f32_32x32x16_bf16 v[104:119], a[120:123], v[216:219], v[104:119]
    v_exp_f32 v71, v71
    v_cvt_pk_bf16_f32 v62, v68, v69
    v_add_f32 v0, v0, v71
    v_cvt_pk_bf16_f32 v63, v70, v71
    ds_read_b128 v[200:203], v234 offset:3072
    v_mfma_f32_32x32x16_bf16 v[120:135], a[124:127], v[216:219], v[120:135]
    v_permlane16_swap_b32 v44, v60
    v_permlane16_swap_b32 v45, v61
    v_permlane16_swap_b32 v46, v62
    v_permlane16_swap_b32 v47, v63
    ds_read_b128 v[204:207], v235 offset:3072
    ds_read_b128 v[208:211], v232 offset:3072
    v_mfma_f32_32x32x16_bf16 v[136:151], a[128:131], v[216:219], v[136:151]
    ds_read_b128 v[212:215], v233 offset:3072
    ds_read_b128 v[216:219], v234 offset:4096
    v_max3_f32 v246, v72, v73, v74
    v_max3_f32 v246, v246, v75, v76
    v_max3_f32 v246, v246, v77, v78
    v_max3_f32 v246, v246, v79, v80
    v_mfma_f32_32x32x16_bf16 v[104:119], a[132:135], v[220:223], v[104:119]
    v_max3_f32 v246, v246, v81, v82
    v_max3_f32 v246, v246, v83, v84
    v_max3_f32 v246, v246, v85, v86
    v_max3_f32 v246, v246, v87, v88
    v_max3_f32 v246, v246, v89, v90
    v_max3_f32 v246, v246, v91, v92
    v_mfma_f32_32x32x16_bf16 v[120:135], a[136:139], v[220:223], v[120:135]
    v_max3_f32 v246, v246, v93, v94
    v_max3_f32 v246, v246, v95, v96
    v_max3_f32 v246, v246, v97, v98
    v_max3_f32 v246, v246, v99, v100
    v_max3_f32 v246, v246, v101, v102
    v_cvt_pk_bf16_f32 v104, v104, v105
    v_mfma_f32_32x32x16_bf16 v[136:151], a[140:143], v[220:223], v[136:151]
    v_cvt_pk_bf16_f32 v105, v106, v107
    v_cvt_pk_bf16_f32 v106, v108, v109
    v_cvt_pk_bf16_f32 v107, v110, v111
    v_cvt_pk_bf16_f32 v108, v112, v113
    v_cvt_pk_bf16_f32 v110, v116, v117
    v_cvt_pk_bf16_f32 v111, v118, v119
    v_mfma_f32_16x16x32_bf16 v[48:51], v[176:179], v[40:43], 0
    v_cvt_pk_bf16_f32 v112, v120, v121
    v_cvt_pk_bf16_f32 v113, v122, v123
    v_mfma_f32_16x16x32_bf16 v[52:55], v[180:183], v[40:43], 0
    v_cvt_pk_bf16_f32 v116, v128, v129
    v_cvt_pk_bf16_f32 v117, v130, v131
    v_mfma_f32_16x16x32_bf16 v[224:227], v[184:187], v[40:43], 0
    v_cvt_pk_bf16_f32 v118, v132, v133
    v_cvt_pk_bf16_f32 v119, v134, v135
    v_mfma_f32_16x16x32_bf16 v[64:67], v[176:179], v[56:59], 0
    v_cvt_pk_bf16_f32 v120, v136, v137
    v_cvt_pk_bf16_f32 v121, v138, v139
    v_mfma_f32_16x16x32_bf16 v[68:71], v[180:183], v[56:59], 0
    v_cvt_pk_bf16_f32 v122, v140, v141
    v_cvt_pk_bf16_f32 v123, v142, v143
    v_mfma_f32_16x16x32_bf16 v[228:231], v[184:187], v[56:59], 0
    v_cvt_pk_bf16_f32 v109, v114, v115
    v_cvt_pk_bf16_f32 v114, v124, v125
    v_mfma_f32_16x16x32_bf16 v[48:51], v[188:191], v[44:47], v[48:51]
    v_cvt_pk_bf16_f32 v115, v126, v127
    v_cvt_pk_bf16_f32 v124, v144, v145
    v_mfma_f32_16x16x32_bf16 v[52:55], v[192:195], v[44:47], v[52:55]
    v_cvt_pk_bf16_f32 v125, v146, v147
    v_cvt_pk_bf16_f32 v126, v148, v149
    v_mfma_f32_16x16x32_bf16 v[224:227], v[196:199], v[44:47], v[224:227]
    v_cvt_pk_bf16_f32 v127, v150, v151
    ds_read_b128 v[220:223], v235 offset:4096
    v_mfma_f32_16x16x32_bf16 v[64:67], v[188:191], v[60:63], v[64:67]
    v_max_f32 v246, v246, v103
    v_fma_f32 v246, v246, s29, v245
    v_mfma_f32_16x16x32_bf16 v[68:71], v[192:195], v[60:63], v[68:71]
    v_mov_b32 v3, v246
    v_mov_b32 v1, v0
    v_mfma_f32_16x16x32_bf16 v[228:231], v[196:199], v[60:63], v[228:231]
    v_permlane32_swap_b32 v246, v3
    s_waitcnt lgkmcnt(1)
    v_mfma_f32_32x32x16_bf16 v[128:143], a[0:3], v[200:203], 0
    v_max_f32 v246, v246, v3
    v_sub_f32 v246, v245, v246
    v_fma_f32 v72, v72, s29, v246
    v_fma_f32 v73, v73, s29, v246
    v_exp_f32 v72, v72
    v_mfma_f32_32x32x16_bf16 v[144:159], a[4:7], v[200:203], 0
    v_exp_f32 v73, v73
    v_fma_f32 v88, v88, s29, v246
    v_exp_f32 v88, v88
    v_fma_f32 v89, v89, s29, v246
    v_mfma_f32_32x32x16_bf16 v[160:175], a[8:11], v[200:203], 0
    ds_read_b128 v[200:203], v232 offset:4096
    v_exp_f32 v89, v89
    v_fma_f32 v74, v74, s29, v246
    v_add_f32 v2, v72, v73
    v_fma_f32 v75, v75, s29, v246
    v_mfma_f32_32x32x16_bf16 v[128:143], a[12:15], v[204:207], v[128:143]
    v_exp_f32 v74, v74
    v_add_f32 v2, v2, v88
    v_exp_f32 v75, v75
    v_fma_f32 v90, v90, s29, v246
    v_mfma_f32_32x32x16_bf16 v[144:159], a[16:19], v[204:207], v[144:159]
    v_add_f32 v2, v2, v89
    v_exp_f32 v90, v90
    v_fma_f32 v91, v91, s29, v246
    v_add_f32 v2, v2, v74
    v_fma_f32 v76, v76, s29, v246
    v_mfma_f32_32x32x16_bf16 v[160:175], a[20:23], v[204:207], v[160:175]
    ds_read_b128 v[204:207], v233 offset:4096
    v_exp_f32 v91, v91
    v_add_f32 v2, v2, v75
    v_exp_f32 v76, v76
    v_mfma_f32_32x32x16_bf16 v[128:143], a[24:27], v[208:211], v[128:143]
    v_fma_f32 v77, v77, s29, v246
    v_add_f32 v2, v2, v90
    v_exp_f32 v77, v77
    v_fma_f32 v92, v92, s29, v246
    v_add_f32 v2, v2, v91
    v_mfma_f32_32x32x16_bf16 v[144:159], a[28:31], v[208:211], v[144:159]
    v_exp_f32 v92, v92
    v_fma_f32 v93, v93, s29, v246
    v_add_f32 v2, v2, v76
    v_exp_f32 v93, v93
    v_mfma_f32_32x32x16_bf16 v[160:175], a[32:35], v[208:211], v[160:175]
    ds_read_b128 v[208:211], v234 offset:5120
    v_fma_f32 v78, v78, s29, v246
    v_add_f32 v2, v2, v77
    v_exp_f32 v78, v78
    v_fma_f32 v79, v79, s29, v246
    v_mfma_f32_32x32x16_bf16 v[128:143], a[36:39], v[212:215], v[128:143]
    v_add_f32 v2, v2, v92
    v_exp_f32 v79, v79
    v_fma_f32 v94, v94, s29, v246
    v_add_f32 v2, v2, v93
    v_fma_f32 v95, v95, s29, v246
    v_mfma_f32_32x32x16_bf16 v[144:159], a[40:43], v[212:215], v[144:159]
    v_exp_f32 v94, v94
    v_add_f32 v2, v2, v78
    v_exp_f32 v95, v95
    v_fma_f32 v80, v80, s29, v246
    v_mfma_f32_32x32x16_bf16 v[160:175], a[44:47], v[212:215], v[160:175]
    ds_read_b128 v[212:215], v235 offset:5120
    v_add_f32 v2, v2, v79
    v_exp_f32 v80, v80
    v_fma_f32 v81, v81, s29, v246
    v_add_f32 v2, v2, v94
    v_mfma_f32_32x32x16_bf16 v[128:143], a[48:51], v[216:219], v[128:143]
    v_exp_f32 v81, v81
    v_fma_f32 v96, v96, s29, v246
    v_add_f32 v2, v2, v95
    v_exp_f32 v96, v96
    v_mfma_f32_32x32x16_bf16 v[144:159], a[52:55], v[216:219], v[144:159]
    v_fma_f32 v97, v97, s29, v246
    v_add_f32 v2, v2, v80
    v_exp_f32 v97, v97
    v_fma_f32 v82, v82, s29, v246
    v_add_f32 v2, v2, v81
    v_mfma_f32_32x32x16_bf16 v[160:175], a[56:59], v[216:219], v[160:175]
    ds_read_b128 v[216:219], v232 offset:5120
    v_exp_f32 v82, v82
    v_fma_f32 v83, v83, s29, v246
    v_add_f32 v2, v2, v96
    s_waitcnt lgkmcnt(2)
    v_mfma_f32_32x32x16_bf16 v[128:143], a[60:63], v[220:223], v[128:143]
    v_exp_f32 v83, v83
    v_fma_f32 v98, v98, s29, v246
    v_add_f32 v2, v2, v97
    v_exp_f32 v98, v98
    v_mfma_f32_32x32x16_bf16 v[144:159], a[64:67], v[220:223], v[144:159]
    v_fma_f32 v99, v99, s29, v246
    v_cvt_pk_bf16_f32 v72, v72, v73
    v_cvt_pk_bf16_f32 v88, v88, v89
    v_add_f32 v2, v2, v82
    v_exp_f32 v99, v99
    v_mfma_f32_32x32x16_bf16 v[160:175], a[68:71], v[220:223], v[160:175]
    ds_read_b128 v[220:223], v233 offset:5120
    v_fma_f32 v84, v84, s29, v246
    v_cvt_pk_bf16_f32 v73, v74, v75
    v_cvt_pk_bf16_f32 v89, v90, v91
    v_add_f32 v2, v2, v83
    v_fma_f32 v85, v85, s29, v246
    v_mfma_f32_32x32x16_bf16 v[128:143], a[72:75], v[200:203], v[128:143]
    v_exp_f32 v84, v84
    v_cvt_pk_bf16_f32 v74, v76, v77
    v_cvt_pk_bf16_f32 v90, v92, v93
    v_cvt_pk_bf16_f32 v75, v78, v79
    v_cvt_pk_bf16_f32 v91, v94, v95
    v_mfma_f32_32x32x16_bf16 v[144:159], a[76:79], v[200:203], v[144:159]
    v_add_f32 v2, v2, v98
    v_exp_f32 v85, v85
    v_fma_f32 v100, v100, s29, v246
    v_permlane16_swap_b32 v72, v88
    v_permlane16_swap_b32 v73, v89
    v_mfma_f32_32x32x16_bf16 v[160:175], a[80:83], v[200:203], v[160:175]
    v_permlane16_swap_b32 v74, v90
    v_permlane16_swap_b32 v75, v91
    v_add_f32 v2, v2, v99
    v_exp_f32 v100, v100
    v_fma_f32 v101, v101, s29, v246
    v_mfma_f32_32x32x16_bf16 v[128:143], a[84:87], v[204:207], v[128:143]
    v_add_f32 v2, v2, v84
    v_exp_f32 v101, v101
    v_fma_f32 v86, v86, s29, v246
    v_cvt_pk_bf16_f32 v76, v80, v81
    v_cvt_pk_bf16_f32 v77, v82, v83
    v_mfma_f32_32x32x16_bf16 v[144:159], a[88:91], v[204:207], v[144:159]
    v_add_f32 v2, v2, v85
    v_exp_f32 v86, v86
    v_fma_f32 v87, v87, s29, v246
    v_add_f32 v2, v2, v100
    v_add_f32 v2, v2, v101
    v_mfma_f32_32x32x16_bf16 v[160:175], a[92:95], v[204:207], v[160:175]
    v_exp_f32 v87, v87
    v_add_f32 v2, v2, v86
    v_cvt_pk_bf16_f32 v78, v84, v85
    v_add_f32 v2, v2, v87
    v_cvt_pk_bf16_f32 v79, v86, v87
    v_mfma_f32_32x32x16_bf16 v[128:143], a[96:99], v[208:211], v[128:143]
    v_fma_f32 v102, v102, s29, v246
    v_cvt_pk_bf16_f32 v92, v96, v97
    v_cvt_pk_bf16_f32 v93, v98, v99
    v_exp_f32 v102, v102
    v_fma_f32 v103, v103, s29, v246
    v_mfma_f32_32x32x16_bf16 v[144:159], a[100:103], v[208:211], v[144:159]
    v_exp_f32 v103, v103
    v_add_f32 v2, v2, v102
    v_cvt_pk_bf16_f32 v94, v100, v101
    v_add_f32 v2, v2, v103
    v_cvt_pk_bf16_f32 v95, v102, v103
    v_mfma_f32_32x32x16_bf16 v[160:175], a[104:107], v[208:211], v[160:175]
    ds_read_b128 v[200:203], v236 offset:0
    v_permlane16_swap_b32 v76, v92
    v_permlane16_swap_b32 v77, v93
    v_permlane16_swap_b32 v78, v94
    v_permlane16_swap_b32 v79, v95
    s_waitcnt lgkmcnt(1)
    v_mfma_f32_32x32x16_bf16 v[128:143], a[108:111], v[212:215], v[128:143]
    ds_read_b128 v[204:207], v237 offset:0
    ds_read_b128 v[208:211], v236 offset:1024
    v_mov_b32 v3, v2
    v_permlane32_swap_b32 v0, v1
    v_add_f32 v0, v0, v1
    v_permlane32_swap_b32 v2, v3
    v_mfma_f32_32x32x16_bf16 v[144:159], a[112:115], v[212:215], v[144:159]
    v_add_f32 v2, v2, v3
    v_rcp_f32 v0, v0
    v_rcp_f32 v2, v2
    v_mov_b32 v1, v0
    v_mfma_f32_32x32x16_bf16 v[160:175], a[116:119], v[212:215], v[160:175]
    ds_read_b128 v[212:215], v237 offset:1024
    v_mov_b32 v3, v2
    v_permlane16_swap_b32 v0, v1
    v_mul_f32 v48, v48, v0
    v_permlane16_swap_b32 v2, v3
    v_mul_f32 v49, v49, v0
    v_mfma_f32_32x32x16_bf16 v[128:143], a[120:123], v[216:219], v[128:143]
    v_mul_f32 v64, v64, v1
    v_mul_f32 v65, v65, v1
    v_mul_f32 v50, v50, v0
    v_mul_f32 v51, v51, v0
    v_cvt_pk_bf16_f32 v48, v48, v49
    v_mul_f32 v224, v224, v0
    v_mfma_f32_32x32x16_bf16 v[144:159], a[124:127], v[216:219], v[144:159]
    v_mul_f32 v225, v225, v0
    v_mul_f32 v66, v66, v1
    v_mul_f32 v67, v67, v1
    v_cvt_pk_bf16_f32 v64, v64, v65
    v_mul_f32 v228, v228, v1
    v_mul_f32 v229, v229, v1
    v_mfma_f32_32x32x16_bf16 v[160:175], a[128:131], v[216:219], v[160:175]
    ds_read_b128 v[216:219], v236 offset:2048
    v_cvt_pk_bf16_f32 v49, v50, v51
    v_mul_f32 v52, v52, v0
    v_mul_f32 v53, v53, v0
    v_mul_f32 v54, v54, v0
    v_mul_f32 v55, v55, v0
    v_mfma_f32_32x32x16_bf16 v[128:143], a[132:135], v[220:223], v[128:143]
    v_mul_f32 v226, v226, v0
    v_mul_f32 v227, v227, v0
    v_cvt_pk_bf16_f32 v224, v224, v225
    v_cvt_pk_bf16_f32 v65, v66, v67
    v_mul_f32 v68, v68, v1
    v_mul_f32 v69, v69, v1
    v_mfma_f32_32x32x16_bf16 v[144:159], a[136:139], v[220:223], v[144:159]
    v_mul_f32 v70, v70, v1
    v_mul_f32 v71, v71, v1
    v_mul_f32 v230, v230, v1
    v_mul_f32 v231, v231, v1
    v_cvt_pk_bf16_f32 v228, v228, v229
    v_cvt_pk_bf16_f32 v128, v128, v129
    v_mfma_f32_32x32x16_bf16 v[160:175], a[140:143], v[220:223], v[160:175]
    v_cvt_pk_bf16_f32 v129, v130, v131
    v_cvt_pk_bf16_f32 v131, v134, v135
    v_cvt_pk_bf16_f32 v134, v140, v141
    v_cvt_pk_bf16_f32 v135, v142, v143
    v_cvt_pk_bf16_f32 v130, v132, v133
    v_cvt_pk_bf16_f32 v140, v152, v153
    v_mfma_f32_16x16x32_bf16 v[80:83], v[176:179], v[72:75], 0
    v_cvt_pk_bf16_f32 v141, v154, v155
    v_cvt_pk_bf16_f32 v142, v156, v157
    v_mfma_f32_16x16x32_bf16 v[84:87], v[180:183], v[72:75], 0
    v_cvt_pk_bf16_f32 v143, v158, v159
    v_cvt_pk_bf16_f32 v132, v136, v137
    v_mfma_f32_16x16x32_bf16 v[40:43], v[184:187], v[72:75], 0
    v_cvt_pk_bf16_f32 v136, v144, v145
    v_cvt_pk_bf16_f32 v144, v160, v161
    v_mfma_f32_16x16x32_bf16 v[96:99], v[176:179], v[88:91], 0
    v_cvt_pk_bf16_f32 v145, v162, v163
    ds_read_b128 v[220:223], v237 offset:2048
    v_mfma_f32_16x16x32_bf16 v[100:103], v[180:183], v[88:91], 0
    v_cvt_pk_bf16_f32 v137, v146, v147
    v_cvt_pk_bf16_f32 v146, v164, v165
    v_mfma_f32_16x16x32_bf16 v[44:47], v[184:187], v[88:91], 0
    v_cvt_pk_bf16_f32 v147, v166, v167
    v_cvt_pk_bf16_f32 v133, v138, v139
    v_mfma_f32_16x16x32_bf16 v[80:83], v[188:191], v[76:79], v[80:83]
    v_cvt_pk_bf16_f32 v138, v148, v149
    v_cvt_pk_bf16_f32 v148, v168, v169
    v_mfma_f32_16x16x32_bf16 v[84:87], v[192:195], v[76:79], v[84:87]
    v_cvt_pk_bf16_f32 v149, v170, v171
    v_cvt_pk_bf16_f32 v139, v150, v151
    v_mfma_f32_16x16x32_bf16 v[40:43], v[196:199], v[76:79], v[40:43]
    v_cvt_pk_bf16_f32 v150, v172, v173
    v_cvt_pk_bf16_f32 v151, v174, v175
    v_mfma_f32_16x16x32_bf16 v[96:99], v[188:191], v[92:95], v[96:99]
    v_mul_f32 v80, v80, v2
    v_mul_f32 v81, v81, v2
    v_mfma_f32_16x16x32_bf16 v[100:103], v[192:195], v[92:95], v[100:103]
    v_mul_f32 v82, v82, v2
    v_mul_f32 v83, v83, v2
    v_mfma_f32_16x16x32_bf16 v[44:47], v[196:199], v[92:95], v[44:47]
    v_cvt_pk_bf16_f32 v80, v80, v81
    s_waitcnt lgkmcnt(1)
    v_mfma_f32_16x16x32_bf16 v[152:155], v[200:203], a[144:147], 0
    v_mul_f32 v96, v96, v3
    v_mul_f32 v97, v97, v3
    v_mfma_f32_16x16x32_bf16 v[156:159], v[200:203], a[148:151], 0
    v_mul_f32 v40, v40, v2
    v_mul_f32 v41, v41, v2
    v_mfma_f32_16x16x32_bf16 v[160:163], v[200:203], a[152:155], 0
    ds_read_b128 v[200:203], v237 offset:6144
    v_mul_f32 v98, v98, v3
    v_mfma_f32_16x16x32_bf16 v[152:155], v[204:207], a[156:159], v[152:155]
    v_mul_f32 v99, v99, v3
    v_cvt_pk_bf16_f32 v96, v96, v97
    v_mfma_f32_16x16x32_bf16 v[156:159], v[204:207], a[160:163], v[156:159]
    v_mul_f32 v44, v44, v3
    v_mul_f32 v45, v45, v3
    v_mfma_f32_16x16x32_bf16 v[160:163], v[204:207], a[164:167], v[160:163]
    ds_read_b128 v[204:207], v236 offset:6144
    v_cvt_pk_bf16_f32 v81, v82, v83
    v_mfma_f32_16x16x32_bf16 v[152:155], v[208:211], a[168:171], v[152:155]
    v_mul_f32 v84, v84, v2
    v_mul_f32 v85, v85, v2
    v_mfma_f32_16x16x32_bf16 v[156:159], v[208:211], a[172:175], v[156:159]
    v_mul_f32 v86, v86, v2
    v_mul_f32 v87, v87, v2
    v_mfma_f32_16x16x32_bf16 v[160:163], v[208:211], a[176:179], v[160:163]
    ds_read_b128 v[208:211], v237 offset:7168
    v_mul_f32 v42, v42, v2
    v_mfma_f32_16x16x32_bf16 v[152:155], v[212:215], a[180:183], v[152:155]
    v_mul_f32 v43, v43, v2
    v_cvt_pk_bf16_f32 v40, v40, v41
    v_mfma_f32_16x16x32_bf16 v[156:159], v[212:215], a[184:187], v[156:159]
    v_cvt_pk_bf16_f32 v97, v98, v99
    v_mul_f32 v100, v100, v3
    v_mfma_f32_16x16x32_bf16 v[160:163], v[212:215], a[188:191], v[160:163]
    ds_read_b128 v[212:215], v236 offset:7168
    v_mul_f32 v101, v101, v3
    v_mfma_f32_16x16x32_bf16 v[152:155], v[216:219], a[192:195], v[152:155]
    v_mul_f32 v102, v102, v3
    v_mul_f32 v103, v103, v3
    v_mfma_f32_16x16x32_bf16 v[156:159], v[216:219], a[196:199], v[156:159]
    v_mul_f32 v46, v46, v3
    v_mul_f32 v47, v47, v3
    v_mfma_f32_16x16x32_bf16 v[160:163], v[216:219], a[200:203], v[160:163]
    ds_read_b128 v[216:219], v237 offset:8192
    s_waitcnt lgkmcnt(4)
    v_mfma_f32_16x16x32_bf16 v[152:155], v[220:223], a[204:207], v[152:155]
    v_cvt_pk_bf16_f32 v44, v44, v45
    v_cvt_pk_bf16_f32 v50, v52, v53
    v_mfma_f32_16x16x32_bf16 v[156:159], v[220:223], a[208:211], v[156:159]
    v_cvt_pk_bf16_f32 v51, v54, v55
    v_cvt_pk_bf16_f32 v225, v226, v227
    v_mfma_f32_16x16x32_bf16 v[160:163], v[220:223], a[212:215], v[160:163]
    ds_read_b128 v[220:223], v236 offset:8192
    v_cvt_pk_bf16_f32 v66, v68, v69
    v_mfma_f32_16x16x32_bf16 v[164:167], v[200:203], a[144:147], 0
    v_cvt_pk_bf16_f32 v176, v152, v153
    v_cvt_pk_bf16_f32 v177, v154, v155
    v_mfma_f32_16x16x32_bf16 v[168:171], v[200:203], a[148:151], 0
    v_cvt_pk_bf16_f32 v180, v156, v157
    v_cvt_pk_bf16_f32 v181, v158, v159
    v_mfma_f32_16x16x32_bf16 v[172:175], v[200:203], a[152:155], 0
    ds_read_b128 v[200:203], v236 offset:12288
    s_waitcnt lgkmcnt(4)
    v_mfma_f32_16x16x32_bf16 v[164:167], v[204:207], a[156:159], v[164:167]
    v_cvt_pk_bf16_f32 v184, v160, v161
    v_cvt_pk_bf16_f32 v185, v162, v163
    v_mfma_f32_16x16x32_bf16 v[168:171], v[204:207], a[160:163], v[168:171]
    v_cvt_pk_bf16_f32 v67, v70, v71
    v_cvt_pk_bf16_f32 v229, v230, v231
    v_mfma_f32_16x16x32_bf16 v[172:175], v[204:207], a[164:167], v[172:175]
    ds_read_b128 v[204:207], v237 offset:12288
    v_cvt_pk_bf16_f32 v82, v84, v85
    v_mfma_f32_16x16x32_bf16 v[164:167], v[208:211], a[168:171], v[164:167]
    v_cvt_pk_bf16_f32 v83, v86, v87
    v_cvt_pk_bf16_f32 v41, v42, v43
    v_mfma_f32_16x16x32_bf16 v[168:171], v[208:211], a[172:175], v[168:171]
    v_cvt_pk_bf16_f32 v98, v100, v101
    v_cvt_pk_bf16_f32 v99, v102, v103
    v_mfma_f32_16x16x32_bf16 v[172:175], v[208:211], a[176:179], v[172:175]
    ds_read_b128 v[208:211], v236 offset:13312
    s_waitcnt lgkmcnt(4)
    v_mfma_f32_16x16x32_bf16 v[164:167], v[212:215], a[180:183], v[164:167]
    v_cvt_pk_bf16_f32 v45, v46, v47
    ds_read_b128 v[56:59], v241 offset:32768
    v_mfma_f32_16x16x32_bf16 v[168:171], v[212:215], a[184:187], v[168:171]
    ds_write_b128 v239, v[48:51] offset:24576
    v_mfma_f32_16x16x32_bf16 v[172:175], v[212:215], a[188:191], v[172:175]
    ds_read_b128 v[212:215], v237 offset:13312
    ds_read_b128 v[60:63], v241 offset:33792
    v_mfma_f32_16x16x32_bf16 v[164:167], v[216:219], a[192:195], v[164:167]
    ds_read_b128 v[68:71], v241 offset:35840
    ds_read_b128 v[72:75], v241 offset:36864
    v_mfma_f32_16x16x32_bf16 v[168:171], v[216:219], a[196:199], v[168:171]
    ds_write_b64 v240, v[224:225] offset:24576
    v_mfma_f32_16x16x32_bf16 v[172:175], v[216:219], a[200:203], v[172:175]
    ds_read_b128 v[216:219], v236 offset:14336
    s_waitcnt lgkmcnt(10)
    v_mfma_f32_16x16x32_bf16 v[164:167], v[220:223], a[204:207], v[164:167]
    ds_read_b128 v[76:79], v241 offset:37888
    ds_read_b128 v[88:91], v241 offset:38912
    v_mfma_f32_16x16x32_bf16 v[168:171], v[220:223], a[208:211], v[168:171]
    ds_write_b128 v239, v[64:67] offset:30720
    v_mfma_f32_16x16x32_bf16 v[172:175], v[220:223], a[212:215], v[172:175]
    ds_read_b128 v[220:223], v237 offset:14336
    ds_read_b128 v[64:67], v241 offset:34816
    v_mfma_f32_16x16x32_bf16 v[152:155], v[200:203], a[144:147], 0
    v_cvt_pk_bf16_f32 v178, v164, v165
    v_cvt_pk_bf16_f32 v179, v166, v167
    v_mfma_f32_16x16x32_bf16 v[156:159], v[200:203], a[148:151], 0
    v_cvt_pk_bf16_f32 v182, v168, v169
    v_cvt_pk_bf16_f32 v183, v170, v171
    v_mfma_f32_16x16x32_bf16 v[160:163], v[200:203], a[152:155], 0
    ds_read_b128 v[200:203], v237 offset:18432
    s_waitcnt lgkmcnt(12)
    v_mfma_f32_16x16x32_bf16 v[152:155], v[204:207], a[156:159], v[152:155]
    v_cvt_pk_bf16_f32 v186, v172, v173
    v_cvt_pk_bf16_f32 v187, v174, v175
    v_mfma_f32_16x16x32_bf16 v[156:159], v[204:207], a[160:163], v[156:159]
    ds_write_b64 v240, v[228:229] offset:30720
    v_mfma_f32_16x16x32_bf16 v[160:163], v[204:207], a[164:167], v[160:163]
    ds_read_b128 v[204:207], v236 offset:18432
    ds_read_b128 v[92:95], v241 offset:39936
    v_mfma_f32_16x16x32_bf16 v[152:155], v[208:211], a[168:171], v[152:155]
    v_readlane_b32 s33, v244, 17
    v_mad_i32_i24 v250, v253, s39, v250
    v_mfma_f32_16x16x32_bf16 v[156:159], v[208:211], a[172:175], v[156:159]
    ds_write_b128 v239, v[80:83] offset:36864
    v_mfma_f32_16x16x32_bf16 v[160:163], v[208:211], a[176:179], v[160:163]
    ds_read_b128 v[208:211], v237 offset:19456
    s_waitcnt lgkmcnt(8)
    v_mfma_f32_16x16x32_bf16 v[152:155], v[212:215], a[180:183], v[152:155]
    v_mad_i32_i24 v251, v254, s39, v251
    v_mov_b32_dpp v244, v244 row_shl:2 row_mask:0xf bank_mask:0xf
    v_mfma_f32_16x16x32_bf16 v[156:159], v[212:215], a[184:187], v[156:159]
    ds_write_b64 v240, v[40:41] offset:36864
    v_mfma_f32_16x16x32_bf16 v[160:163], v[212:215], a[188:191], v[160:163]
    ds_read_b128 v[212:215], v236 offset:19456
    v_mfma_f32_16x16x32_bf16 v[152:155], v[216:219], a[192:195], v[152:155]
    v_mfma_f32_16x16x32_bf16 v[156:159], v[216:219], a[196:199], v[156:159]
    ds_write_b128 v239, v[96:99] offset:43008
    v_mfma_f32_16x16x32_bf16 v[160:163], v[216:219], a[200:203], v[160:163]
    ds_read_b128 v[216:219], v237 offset:20480
    s_waitcnt lgkmcnt(8)
    v_mfma_f32_16x16x32_bf16 v[152:155], v[220:223], a[204:207], v[152:155]
    v_mfma_f32_16x16x32_bf16 v[156:159], v[220:223], a[208:211], v[156:159]
    ds_write_b64 v240, v[44:45] offset:43008
    v_mfma_f32_16x16x32_bf16 v[160:163], v[220:223], a[212:215], v[160:163]
    ds_read_b128 v[220:223], v236 offset:20480
    v_mfma_f32_16x16x32_bf16 v[164:167], v[200:203], a[144:147], 0
    v_mfma_f32_16x16x32_bf16 v[168:171], v[200:203], a[148:151], 0
    v_mfma_f32_16x16x32_bf16 v[172:175], v[200:203], a[152:155], 0
    s_waitcnt lgkmcnt(5)
    v_mfma_f32_16x16x32_bf16 v[164:167], v[204:207], a[156:159], v[164:167]
    v_cvt_pk_bf16_f32 v188, v152, v153
    v_cvt_pk_bf16_f32 v189, v154, v155
    v_mfma_f32_16x16x32_bf16 v[168:171], v[204:207], a[160:163], v[168:171]
    v_cvt_pk_bf16_f32 v192, v156, v157
    v_cvt_pk_bf16_f32 v193, v158, v159
    v_mfma_f32_16x16x32_bf16 v[172:175], v[204:207], a[164:167], v[172:175]
    v_cvt_pk_bf16_f32 v196, v160, v161
    v_cvt_pk_bf16_f32 v197, v162, v163
    v_mfma_f32_16x16x32_bf16 v[164:167], v[208:211], a[168:171], v[164:167]
    v_mfma_f32_16x16x32_bf16 v[168:171], v[208:211], a[172:175], v[168:171]
    s_waitcnt vmcnt(0) lgkmcnt(0)
    v_mfma_f32_16x16x32_bf16 v[172:175], v[208:211], a[176:179], v[172:175]
    s_barrier
    v_mfma_f32_16x16x32_bf16 v[164:167], v[212:215], a[180:183], v[164:167]
    ds_read_b128 v[200:203], v238 offset:24576
    ds_read_b128 v[204:207], v238 offset:25600
    v_mfma_f32_16x16x32_bf16 v[168:171], v[212:215], a[184:187], v[168:171]
    ds_read_b128 v[208:211], v238 offset:28672
    v_mfma_f32_16x16x32_bf16 v[172:175], v[212:215], a[188:191], v[172:175]
    ds_read_b128 v[212:215], v238 offset:26624
    v_mfma_f32_16x16x32_bf16 v[164:167], v[216:219], a[192:195], v[164:167]
    v_mfma_f32_16x16x32_bf16 v[168:171], v[216:219], a[196:199], v[168:171]
    v_mfma_f32_16x16x32_bf16 v[172:175], v[216:219], a[200:203], v[172:175]
    ds_read_b128 v[216:219], v238 offset:27648
    v_mfma_f32_16x16x32_bf16 v[164:167], v[220:223], a[204:207], v[164:167]
    v_mfma_f32_16x16x32_bf16 v[168:171], v[220:223], a[208:211], v[168:171]
    v_mfma_f32_16x16x32_bf16 v[172:175], v[220:223], a[212:215], v[172:175]
    ds_read_b128 v[220:223], v238 offset:29696
    s_waitcnt lgkmcnt(5)
    v_mfma_f32_16x16x32_bf16 v[152:155], a[216:219], v[200:203], 0
    v_mfma_f32_16x16x32_bf16 v[156:159], a[220:223], v[200:203], 0
    v_mfma_f32_16x16x32_bf16 v[160:163], a[224:227], v[200:203], 0
    ds_read_b128 v[200:203], v238 offset:36864
    s_waitcnt lgkmcnt(4)
    v_mfma_f32_16x16x32_bf16 v[152:155], a[228:231], v[204:207], v[152:155]
    v_cvt_pk_bf16_f32 v190, v164, v165
    v_cvt_pk_bf16_f32 v191, v166, v167
    v_mfma_f32_16x16x32_bf16 v[156:159], a[232:235], v[204:207], v[156:159]
    v_cvt_pk_bf16_f32 v194, v168, v169
    v_cvt_pk_bf16_f32 v195, v170, v171
    v_mfma_f32_16x16x32_bf16 v[160:163], a[236:239], v[204:207], v[160:163]
    ds_read_b128 v[204:207], v238 offset:37888
    v_cvt_pk_bf16_f32 v198, v172, v173
    v_mfma_f32_16x16x32_bf16 v[152:155], a[240:243], v[208:211], v[152:155]
    v_cvt_pk_bf16_f32 v199, v174, v175
    v_mfma_f32_16x16x32_bf16 v[156:159], a[244:247], v[208:211], v[156:159]
    v_mfma_f32_16x16x32_bf16 v[160:163], a[248:251], v[208:211], v[160:163]
    ds_read_b128 v[208:211], v238 offset:40960
    s_waitcnt lgkmcnt(4)
    v_mfma_f32_16x16x32_bf16 v[152:155], a[252:255], v[212:215], v[152:155]
    v_mfma_f32_16x16x32_bf16 v[156:159], v[56:59], v[212:215], v[156:159]
    v_mfma_f32_16x16x32_bf16 v[160:163], v[60:63], v[212:215], v[160:163]
    ds_read_b128 v[212:215], v238 offset:38912
    v_mfma_f32_16x16x32_bf16 v[152:155], v[64:67], v[216:219], v[152:155]
    v_mfma_f32_16x16x32_bf16 v[156:159], v[68:71], v[216:219], v[156:159]
    v_mfma_f32_16x16x32_bf16 v[160:163], v[72:75], v[216:219], v[160:163]
    ds_read_b128 v[216:219], v238 offset:39936
    s_waitcnt lgkmcnt(4)
    v_mfma_f32_16x16x32_bf16 v[152:155], v[76:79], v[220:223], v[152:155]
    v_mfma_f32_16x16x32_bf16 v[156:159], v[88:91], v[220:223], v[156:159]
    v_mfma_f32_16x16x32_bf16 v[160:163], v[92:95], v[220:223], v[160:163]
    ds_read_b128 v[220:223], v238 offset:41984
    v_mfma_f32_16x16x32_bf16 v[164:167], a[216:219], v[200:203], 0
    v_mfma_f32_16x16x32_bf16 v[168:171], a[220:223], v[200:203], 0
    v_mfma_f32_16x16x32_bf16 v[172:175], a[224:227], v[200:203], 0
    ds_read_b128 v[200:203], v238 offset:30720
    s_waitcnt lgkmcnt(4)
    v_mfma_f32_16x16x32_bf16 v[164:167], a[228:231], v[204:207], v[164:167]
    v_cvt_pk_bf16_f32 v152, v152, v153
    v_cvt_pk_bf16_f32 v153, v154, v155
    v_mfma_f32_16x16x32_bf16 v[168:171], a[232:235], v[204:207], v[168:171]
    v_cvt_pk_bf16_f32 v154, v156, v157
    v_cvt_pk_bf16_f32 v155, v158, v159
    v_mfma_f32_16x16x32_bf16 v[172:175], a[236:239], v[204:207], v[172:175]
    ds_read_b128 v[204:207], v238 offset:31744
    v_cvt_pk_bf16_f32 v160, v160, v161
    v_mfma_f32_16x16x32_bf16 v[164:167], a[240:243], v[208:211], v[164:167]
    ds_write_b128 v247, v[152:155] offset:0
    v_mfma_f32_16x16x32_bf16 v[168:171], a[244:247], v[208:211], v[168:171]
    v_cvt_pk_bf16_f32 v161, v162, v163
    v_mfma_f32_16x16x32_bf16 v[172:175], a[248:251], v[208:211], v[172:175]
    ds_read_b128 v[208:211], v238 offset:34816
    s_waitcnt lgkmcnt(5)
    v_mfma_f32_16x16x32_bf16 v[164:167], a[252:255], v[212:215], v[164:167]
    ds_write_b64 v248, v[160:161] offset:0
    v_mfma_f32_16x16x32_bf16 v[168:171], v[56:59], v[212:215], v[168:171]
    v_mfma_f32_16x16x32_bf16 v[172:175], v[60:63], v[212:215], v[172:175]
    ds_read_b128 v[212:215], v238 offset:32768
    v_mfma_f32_16x16x32_bf16 v[164:167], v[64:67], v[216:219], v[164:167]
    v_mfma_f32_16x16x32_bf16 v[168:171], v[68:71], v[216:219], v[168:171]
    v_mfma_f32_16x16x32_bf16 v[172:175], v[72:75], v[216:219], v[172:175]
    ds_read_b128 v[216:219], v238 offset:33792
    s_waitcnt lgkmcnt(6)
    v_mfma_f32_16x16x32_bf16 v[164:167], v[76:79], v[220:223], v[164:167]
    v_mfma_f32_16x16x32_bf16 v[168:171], v[88:91], v[220:223], v[168:171]
    v_mfma_f32_16x16x32_bf16 v[172:175], v[92:95], v[220:223], v[172:175]
    ds_read_b128 v[220:223], v238 offset:35840
    v_mfma_f32_16x16x32_bf16 v[152:155], a[216:219], v[200:203], 0
    v_mfma_f32_16x16x32_bf16 v[156:159], a[220:223], v[200:203], 0
    v_mfma_f32_16x16x32_bf16 v[160:163], a[224:227], v[200:203], 0
    ds_read_b128 v[200:203], v238 offset:43008
    s_waitcnt lgkmcnt(4)
    v_mfma_f32_16x16x32_bf16 v[152:155], a[228:231], v[204:207], v[152:155]
    v_cvt_pk_bf16_f32 v164, v164, v165
    v_cvt_pk_bf16_f32 v165, v166, v167
    v_mfma_f32_16x16x32_bf16 v[156:159], a[232:235], v[204:207], v[156:159]
    v_cvt_pk_bf16_f32 v166, v168, v169
    v_cvt_pk_bf16_f32 v167, v170, v171
    v_mfma_f32_16x16x32_bf16 v[160:163], a[236:239], v[204:207], v[160:163]
    ds_read_b128 v[204:207], v238 offset:44032
    v_cvt_pk_bf16_f32 v172, v172, v173
    v_mfma_f32_16x16x32_bf16 v[152:155], a[240:243], v[208:211], v[152:155]
    ds_write_b128 v247, v[164:167] offset:768
    v_mfma_f32_16x16x32_bf16 v[156:159], a[244:247], v[208:211], v[156:159]
    v_cvt_pk_bf16_f32 v173, v174, v175
    v_mfma_f32_16x16x32_bf16 v[160:163], a[248:251], v[208:211], v[160:163]
    ds_read_b128 v[208:211], v238 offset:47104
    s_waitcnt lgkmcnt(5)
    v_mfma_f32_16x16x32_bf16 v[152:155], a[252:255], v[212:215], v[152:155]
    ds_write_b64 v248, v[172:173] offset:768
    v_mfma_f32_16x16x32_bf16 v[156:159], v[56:59], v[212:215], v[156:159]
    ds_read_b128 v[40:43], v241 offset:0
    ds_read_b128 v[44:47], v241 offset:1024
    v_mfma_f32_16x16x32_bf16 v[160:163], v[60:63], v[212:215], v[160:163]
    ds_read_b128 v[212:215], v238 offset:45056
    ds_read_b128 v[48:51], v241 offset:2048
    v_mfma_f32_16x16x32_bf16 v[152:155], v[64:67], v[216:219], v[152:155]
    v_mfma_f32_16x16x32_bf16 v[156:159], v[68:71], v[216:219], v[156:159]
    v_mfma_f32_16x16x32_bf16 v[160:163], v[72:75], v[216:219], v[160:163]
    ds_read_b128 v[216:219], v238 offset:46080
    s_waitcnt lgkmcnt(9)
    v_mfma_f32_16x16x32_bf16 v[152:155], v[76:79], v[220:223], v[152:155]
    v_mfma_f32_16x16x32_bf16 v[156:159], v[88:91], v[220:223], v[156:159]
    v_mfma_f32_16x16x32_bf16 v[160:163], v[92:95], v[220:223], v[160:163]
    ds_read_b128 v[220:223], v238 offset:48128
    v_mfma_f32_16x16x32_bf16 v[164:167], a[216:219], v[200:203], 0
    v_mfma_f32_16x16x32_bf16 v[168:171], a[220:223], v[200:203], 0
    v_mfma_f32_16x16x32_bf16 v[172:175], a[224:227], v[200:203], 0
    s_waitcnt lgkmcnt(5)
    v_mfma_f32_16x16x32_bf16 v[164:167], a[228:231], v[204:207], v[164:167]
    v_cvt_pk_bf16_f32 v152, v152, v153
    v_cvt_pk_bf16_f32 v153, v154, v155
    v_mfma_f32_16x16x32_bf16 v[168:171], a[232:235], v[204:207], v[168:171]
    v_cvt_pk_bf16_f32 v154, v156, v157
    v_cvt_pk_bf16_f32 v155, v158, v159
    v_mfma_f32_16x16x32_bf16 v[172:175], a[236:239], v[204:207], v[172:175]
    v_cvt_pk_bf16_f32 v160, v160, v161
    v_cvt_pk_bf16_f32 v161, v162, v163
    v_mfma_f32_16x16x32_bf16 v[164:167], a[240:243], v[208:211], v[164:167]
    ds_write_b128 v247, v[152:155] offset:3072
    v_mfma_f32_16x16x32_bf16 v[168:171], a[244:247], v[208:211], v[168:171]
    buffer_store_dwordx4 v[40:43], v249, s[12:15], s32 offen nt
    v_mfma_f32_16x16x32_bf16 v[172:175], a[248:251], v[208:211], v[172:175]
    s_waitcnt lgkmcnt(2)
    v_mfma_f32_16x16x32_bf16 v[164:167], a[252:255], v[212:215], v[164:167]
    ds_write_b64 v248, v[160:161] offset:3072
    v_mfma_f32_16x16x32_bf16 v[168:171], v[56:59], v[212:215], v[168:171]
    v_mfma_f32_16x16x32_bf16 v[172:175], v[60:63], v[212:215], v[172:175]
    v_mfma_f32_16x16x32_bf16 v[164:167], v[64:67], v[216:219], v[164:167]
    v_mfma_f32_16x16x32_bf16 v[168:171], v[68:71], v[216:219], v[168:171]
    buffer_store_dwordx4 v[44:47], v250, s[12:15], s32 offen nt
    v_mfma_f32_16x16x32_bf16 v[172:175], v[72:75], v[216:219], v[172:175]
    s_waitcnt lgkmcnt(2)
    v_mfma_f32_16x16x32_bf16 v[164:167], v[76:79], v[220:223], v[164:167]
    v_mfma_f32_16x16x32_bf16 v[168:171], v[88:91], v[220:223], v[168:171]
    v_mfma_f32_16x16x32_bf16 v[172:175], v[92:95], v[220:223], v[172:175]
    buffer_store_dwordx4 v[48:51], v251, s[12:15], s32 offen nt
    s_waitcnt lgkmcnt(0)
    s_add_u32 s30, s30, 1
    s_cmp_eq_u32 s30, 3
    s_cselect_b32 s10, 0, s10
    s_cmp_eq_u32 s30, 4
    s_cbranch_scc1 LAST
    v_mfma_f32_32x32x16_bf16 v[40:55], v[116:119], v[104:107], v[4:19]
    ds_read_b128 v[200:203], v232 offset:24576
    v_cvt_pk_bf16_f32 v164, v164, v165
    v_cvt_pk_bf16_f32 v165, v166, v167
    v_cvt_pk_bf16_f32 v166, v168, v169
    v_cvt_pk_bf16_f32 v167, v170, v171
    ds_read_b128 v[204:207], v233 offset:24576
    v_mfma_f32_32x32x16_bf16 v[56:71], v[140:143], v[104:107], v[24:39]
    v_cvt_pk_bf16_f32 v172, v172, v173
    ds_write_b128 v247, v[164:167] offset:3840
    v_cvt_pk_bf16_f32 v173, v174, v175
    ds_read_b128 v[208:211], v234 offset:24576
    ds_read_b128 v[212:215], v235 offset:24576
    v_mfma_f32_32x32x16_bf16 v[40:55], v[120:123], v[108:111], v[40:55]
    ds_read_b128 v[216:219], v232 offset:25600
    ds_read_b128 v[220:223], v233 offset:25600
    v_readlane_b32 s40, v244, 48
    ds_write_b64 v248, v[172:173] offset:3840
    ds_read_b128 v[152:155], v241 offset:3072
    v_mfma_f32_32x32x16_bf16 v[56:71], v[144:147], v[108:111], v[56:71]
    ds_read_b128 v[156:159], v241 offset:4096
    ds_read_b128 v[160:163], v241 offset:5120
    v_mov_b32 v245, s40
    v_readlane_b32 s38, v244, 34
    v_cndmask_b32 v245, 0, v245, s[42:43]
    v_readlane_b32 s36, v244, 2
    v_mfma_f32_32x32x16_bf16 v[40:55], v[124:127], v[112:115], v[40:55]
    v_mad_i32_i24 v242, v243, s38, v242
    s_add_u32 m0, s31, 0
    v_readlane_b32 s37, v244, 18
    v_readlane_b32 s39, v244, 32
    v_readlane_b32 s32, v244, 0
    v_mfma_f32_32x32x16_bf16 v[56:71], v[148:151], v[112:115], v[56:71]
    buffer_load_dwordx4 v242, s[4:7], s36 offen offset:0 lds
    s_add_u32 m0, s31, 896
    v_mfma_f32_32x32x16_bf16 v[72:87], v[116:119], v[128:131], v[20:35]
    v_mfma_f32_32x32x16_bf16 v[88:103], v[140:143], v[128:131], v[4:19]
    v_mfma_f32_32x32x16_bf16 v[72:87], v[120:123], v[132:135], v[72:87]
    s_waitcnt lgkmcnt(1)
    buffer_store_dwordx4 v[152:155], v249, s[12:15], s33 offen nt
    v_max3_f32 v246, v40, v41, v42
    v_max3_f32 v246, v246, v43, v44
    v_max3_f32 v246, v246, v45, v46
    v_mfma_f32_32x32x16_bf16 v[88:103], v[144:147], v[132:135], v[88:103]
    v_max3_f32 v246, v246, v47, v48
    v_max3_f32 v246, v246, v49, v50
    v_max3_f32 v246, v246, v51, v52
    v_max3_f32 v246, v246, v53, v54
    v_max3_f32 v246, v246, v55, v56
    v_max3_f32 v246, v246, v57, v58
    v_mfma_f32_32x32x16_bf16 v[72:87], v[124:127], v[136:139], v[72:87]
    v_max3_f32 v246, v246, v59, v60
    v_max3_f32 v246, v246, v61, v62
    v_max3_f32 v246, v246, v63, v64
    v_max3_f32 v246, v246, v65, v66
    v_max3_f32 v246, v246, v67, v68
    v_max3_f32 v246, v246, v69, v70
    v_mfma_f32_32x32x16_bf16 v[88:103], v[148:151], v[136:139], v[88:103]
    buffer_store_dwordx4 v[156:159], v250, s[12:15], s33 offen nt
    v_max_f32 v246, v246, v71
    v_fma_f32 v246, v246, s29, v245
    v_mov_b32 v1, v246
    v_mad_i32_i24 v249, v252, s39, v249
    v_mfma_f32_32x32x16_bf16 v[104:119], a[0:3], v[200:203], 0
    v_permlane32_swap_b32 v246, v1
    v_max_f32 v246, v246, v1
    v_sub_f32 v246, v245, v246
    v_fma_f32 v40, v40, s29, v246
    v_fma_f32 v41, v41, s29, v246
    v_fma_f32 v56, v56, s29, v246
    v_mfma_f32_32x32x16_bf16 v[120:135], a[4:7], v[200:203], 0
    v_exp_f32 v40, v40
    v_exp_f32 v41, v41
    v_exp_f32 v56, v56
    v_mfma_f32_32x32x16_bf16 v[136:151], a[8:11], v[200:203], 0
    s_waitcnt lgkmcnt(0)
    buffer_store_dwordx4 v[160:163], v251, s[12:15], s33 offen nt
    ds_read_b128 v[200:203], v234 offset:25600
    v_fma_f32 v57, v57, s29, v246
    v_fma_f32 v42, v42, s29, v246
    v_mfma_f32_32x32x16_bf16 v[104:119], a[12:15], v[204:207], v[104:119]
    v_exp_f32 v57, v57
    v_add_f32 v0, v40, v41
    v_exp_f32 v42, v42
    v_fma_f32 v43, v43, s29, v246
    v_mfma_f32_32x32x16_bf16 v[120:135], a[16:19], v[204:207], v[120:135]
    v_add_f32 v0, v0, v56
    v_exp_f32 v43, v43
    v_fma_f32 v58, v58, s29, v246
    v_add_f32 v0, v0, v57
    v_fma_f32 v59, v59, s29, v246
    v_mfma_f32_32x32x16_bf16 v[136:151], a[20:23], v[204:207], v[136:151]
    ds_read_b128 v[204:207], v235 offset:25600
    buffer_load_dwordx4 v242, s[4:7], s36 offen offset:128 lds
    s_add_u32 m0, s31, 1792
    v_mfma_f32_32x32x16_bf16 v[104:119], a[24:27], v[208:211], v[104:119]
    v_exp_f32 v58, v58
    v_add_f32 v0, v0, v42
    v_exp_f32 v59, v59
    v_fma_f32 v44, v44, s29, v246
    v_mfma_f32_32x32x16_bf16 v[120:135], a[28:31], v[208:211], v[120:135]
    v_add_f32 v0, v0, v43
    v_exp_f32 v44, v44
    v_fma_f32 v45, v45, s29, v246
    v_add_f32 v0, v0, v58
    v_fma_f32 v60, v60, s29, v246
    v_mfma_f32_32x32x16_bf16 v[136:151], a[32:35], v[208:211], v[136:151]
    ds_read_b128 v[208:211], v232 offset:26624
    buffer_load_dwordx4 v242, s[4:7], s36 offen offset:256 lds
    s_add_u32 m0, s31, 12288
    v_mfma_f32_32x32x16_bf16 v[104:119], a[36:39], v[212:215], v[104:119]
    v_exp_f32 v45, v45
    v_add_f32 v0, v0, v59
    v_exp_f32 v60, v60
    v_fma_f32 v61, v61, s29, v246
    v_mfma_f32_32x32x16_bf16 v[120:135], a[40:43], v[212:215], v[120:135]
    v_add_f32 v0, v0, v44
    v_exp_f32 v61, v61
    v_fma_f32 v46, v46, s29, v246
    v_add_f32 v0, v0, v45
    v_fma_f32 v47, v47, s29, v246
    v_mfma_f32_32x32x16_bf16 v[136:151], a[44:47], v[212:215], v[136:151]
    ds_read_b128 v[212:215], v233 offset:26624
    buffer_load_dwordx4 v242, s[4:7], s37 offen offset:0 lds
    v_add_f32 v0, v0, v60
    v_mfma_f32_32x32x16_bf16 v[104:119], a[48:51], v[216:219], v[104:119]
    v_exp_f32 v46, v46
    v_exp_f32 v47, v47
    v_fma_f32 v62, v62, s29, v246
    s_add_u32 m0, s31, 13184
    v_mfma_f32_32x32x16_bf16 v[120:135], a[52:55], v[216:219], v[120:135]
    v_add_f32 v0, v0, v61
    v_exp_f32 v62, v62
    v_fma_f32 v63, v63, s29, v246
    v_add_f32 v0, v0, v46
    v_fma_f32 v48, v48, s29, v246
    v_mfma_f32_32x32x16_bf16 v[136:151], a[56:59], v[216:219], v[136:151]
    ds_read_b128 v[216:219], v234 offset:26624
    buffer_load_dwordx4 v242, s[4:7], s37 offen offset:128 lds
    v_add_f32 v0, v0, v47
    v_mfma_f32_32x32x16_bf16 v[104:119], a[60:63], v[220:223], v[104:119]
    v_exp_f32 v63, v63
    v_exp_f32 v48, v48
    v_fma_f32 v49, v49, s29, v246
    v_add_f32 v0, v0, v62
    v_mfma_f32_32x32x16_bf16 v[120:135], a[64:67], v[220:223], v[120:135]
    v_exp_f32 v49, v49
    v_fma_f32 v64, v64, s29, v246
    v_add_f32 v0, v0, v63
    v_exp_f32 v64, v64
    v_mfma_f32_32x32x16_bf16 v[136:151], a[68:71], v[220:223], v[136:151]
    ds_read_b128 v[220:223], v235 offset:26624
    v_fma_f32 v65, v65, s29, v246
    s_add_u32 m0, s31, 14080
    v_add_f32 v0, v0, v48
    v_fma_f32 v50, v50, s29, v246
    s_waitcnt lgkmcnt(2)
    v_mfma_f32_32x32x16_bf16 v[104:119], a[72:75], v[200:203], v[104:119]
    v_exp_f32 v65, v65
    buffer_load_dwordx4 v242, s[4:7], s37 offen offset:256 lds
    v_mfma_f32_32x32x16_bf16 v[120:135], a[76:79], v[200:203], v[120:135]
    v_add_f32 v0, v0, v49
    v_exp_f32 v50, v50
    v_fma_f32 v51, v51, s29, v246
    v_add_f32 v0, v0, v64
    v_fma_f32 v66, v66, s29, v246
    v_mfma_f32_32x32x16_bf16 v[136:151], a[80:83], v[200:203], v[136:151]
    v_exp_f32 v51, v51
    v_add_f32 v0, v0, v65
    v_exp_f32 v66, v66
    v_fma_f32 v67, v67, s29, v246
    v_mfma_f32_32x32x16_bf16 v[104:119], a[84:87], v[204:207], v[104:119]
    v_cvt_pk_bf16_f32 v40, v40, v41
    v_cvt_pk_bf16_f32 v56, v56, v57
    v_add_f32 v0, v0, v50
    v_exp_f32 v67, v67
    v_fma_f32 v52, v52, s29, v246
    v_mfma_f32_32x32x16_bf16 v[120:135], a[88:91], v[204:207], v[120:135]
    v_cvt_pk_bf16_f32 v41, v42, v43
    v_cvt_pk_bf16_f32 v57, v58, v59
    v_add_f32 v0, v0, v51
    v_exp_f32 v52, v52
    v_fma_f32 v53, v53, s29, v246
    v_mfma_f32_32x32x16_bf16 v[136:151], a[92:95], v[204:207], v[136:151]
    v_cvt_pk_bf16_f32 v42, v44, v45
    v_cvt_pk_bf16_f32 v58, v60, v61
    v_cvt_pk_bf16_f32 v43, v46, v47
    v_cvt_pk_bf16_f32 v59, v62, v63
    v_add_f32 v0, v0, v66
    v_fma_f32 v68, v68, s29, v246
    v_mfma_f32_32x32x16_bf16 v[104:119], a[96:99], v[208:211], v[104:119]
    v_exp_f32 v53, v53
    v_permlane16_swap_b32 v40, v56
    v_permlane16_swap_b32 v41, v57
    v_permlane16_swap_b32 v42, v58
    v_permlane16_swap_b32 v43, v59
    v_mfma_f32_32x32x16_bf16 v[120:135], a[100:103], v[208:211], v[120:135]
    v_add_f32 v0, v0, v67
    v_exp_f32 v68, v68
    v_fma_f32 v69, v69, s29, v246
    v_add_f32 v0, v0, v52
    v_fma_f32 v54, v54, s29, v246
    v_mfma_f32_32x32x16_bf16 v[136:151], a[104:107], v[208:211], v[136:151]
    v_exp_f32 v69, v69
    v_cvt_pk_bf16_f32 v44, v48, v49
    v_cvt_pk_bf16_f32 v45, v50, v51
    v_add_f32 v0, v0, v53
    v_fma_f32 v55, v55, s29, v246
    v_mfma_f32_32x32x16_bf16 v[104:119], a[108:111], v[212:215], v[104:119]
    v_exp_f32 v54, v54
    v_add_f32 v0, v0, v68
    v_exp_f32 v55, v55
    v_add_f32 v0, v0, v69
    v_mfma_f32_32x32x16_bf16 v[120:135], a[112:115], v[212:215], v[120:135]
    v_add_f32 v0, v0, v54
    v_cvt_pk_bf16_f32 v46, v52, v53
    v_add_f32 v0, v0, v55
    v_cvt_pk_bf16_f32 v47, v54, v55
    v_fma_f32 v70, v70, s29, v246
    v_cvt_pk_bf16_f32 v60, v64, v65
    v_mfma_f32_32x32x16_bf16 v[136:151], a[116:119], v[212:215], v[136:151]
    v_cvt_pk_bf16_f32 v61, v66, v67
    v_exp_f32 v70, v70
    v_fma_f32 v71, v71, s29, v246
    v_add_f32 v0, v0, v70
    s_waitcnt lgkmcnt(0)
    v_mfma_f32_32x32x16_bf16 v[104:119], a[120:123], v[216:219], v[104:119]
    v_exp_f32 v71, v71
    v_cvt_pk_bf16_f32 v62, v68, v69
    v_add_f32 v0, v0, v71
    v_cvt_pk_bf16_f32 v63, v70, v71
    ds_read_b128 v[200:203], v234 offset:27648
    v_mfma_f32_32x32x16_bf16 v[120:135], a[124:127], v[216:219], v[120:135]
    v_permlane16_swap_b32 v44, v60
    v_permlane16_swap_b32 v45, v61
    v_permlane16_swap_b32 v46, v62
    v_permlane16_swap_b32 v47, v63
    ds_read_b128 v[204:207], v235 offset:27648
    ds_read_b128 v[208:211], v232 offset:27648
    v_mfma_f32_32x32x16_bf16 v[136:151], a[128:131], v[216:219], v[136:151]
    ds_read_b128 v[212:215], v233 offset:27648
    ds_read_b128 v[216:219], v234 offset:28672
    v_max3_f32 v246, v72, v73, v74
    v_max3_f32 v246, v246, v75, v76
    v_max3_f32 v246, v246, v77, v78
    v_max3_f32 v246, v246, v79, v80
    v_mfma_f32_32x32x16_bf16 v[104:119], a[132:135], v[220:223], v[104:119]
    v_max3_f32 v246, v246, v81, v82
    v_max3_f32 v246, v246, v83, v84
    v_max3_f32 v246, v246, v85, v86
    v_max3_f32 v246, v246, v87, v88
    v_max3_f32 v246, v246, v89, v90
    v_max3_f32 v246, v246, v91, v92
    v_mfma_f32_32x32x16_bf16 v[120:135], a[136:139], v[220:223], v[120:135]
    v_max3_f32 v246, v246, v93, v94
    v_max3_f32 v246, v246, v95, v96
    v_max3_f32 v246, v246, v97, v98
    v_max3_f32 v246, v246, v99, v100
    v_max3_f32 v246, v246, v101, v102
    v_cvt_pk_bf16_f32 v104, v104, v105
    v_mfma_f32_32x32x16_bf16 v[136:151], a[140:143], v[220:223], v[136:151]
    v_cvt_pk_bf16_f32 v105, v106, v107
    v_cvt_pk_bf16_f32 v106, v108, v109
    v_cvt_pk_bf16_f32 v107, v110, v111
    v_cvt_pk_bf16_f32 v108, v112, v113
    v_cvt_pk_bf16_f32 v110, v116, v117
    v_cvt_pk_bf16_f32 v111, v118, v119
    v_mfma_f32_16x16x32_bf16 v[48:51], v[176:179], v[40:43], 0
    v_cvt_pk_bf16_f32 v112, v120, v121
    v_cvt_pk_bf16_f32 v113, v122, v123
    v_mfma_f32_16x16x32_bf16 v[52:55], v[180:183], v[40:43], 0
    v_cvt_pk_bf16_f32 v116, v128, v129
    v_cvt_pk_bf16_f32 v117, v130, v131
    v_mfma_f32_16x16x32_bf16 v[224:227], v[184:187], v[40:43], 0
    v_cvt_pk_bf16_f32 v118, v132, v133
    v_cvt_pk_bf16_f32 v119, v134, v135
    v_mfma_f32_16x16x32_bf16 v[64:67], v[176:179], v[56:59], 0
    v_cvt_pk_bf16_f32 v120, v136, v137
    v_cvt_pk_bf16_f32 v121, v138, v139
    v_mfma_f32_16x16x32_bf16 v[68:71], v[180:183], v[56:59], 0
    v_cvt_pk_bf16_f32 v122, v140, v141
    v_cvt_pk_bf16_f32 v123, v142, v143
    v_mfma_f32_16x16x32_bf16 v[228:231], v[184:187], v[56:59], 0
    v_cvt_pk_bf16_f32 v109, v114, v115
    v_cvt_pk_bf16_f32 v114, v124, v125
    v_mfma_f32_16x16x32_bf16 v[48:51], v[188:191], v[44:47], v[48:51]
    v_cvt_pk_bf16_f32 v115, v126, v127
    v_cvt_pk_bf16_f32 v124, v144, v145
    v_mfma_f32_16x16x32_bf16 v[52:55], v[192:195], v[44:47], v[52:55]
    v_cvt_pk_bf16_f32 v125, v146, v147
    v_cvt_pk_bf16_f32 v126, v148, v149
    v_mfma_f32_16x16x32_bf16 v[224:227], v[196:199], v[44:47], v[224:227]
    v_cvt_pk_bf16_f32 v127, v150, v151
    ds_read_b128 v[220:223], v235 offset:28672
    v_mfma_f32_16x16x32_bf16 v[64:67], v[188:191], v[60:63], v[64:67]
    v_max_f32 v246, v246, v103
    v_fma_f32 v246, v246, s29, v245
    v_mfma_f32_16x16x32_bf16 v[68:71], v[192:195], v[60:63], v[68:71]
    v_mov_b32 v3, v246
    v_mov_b32 v1, v0
    v_mfma_f32_16x16x32_bf16 v[228:231], v[196:199], v[60:63], v[228:231]
    v_permlane32_swap_b32 v246, v3
    s_waitcnt lgkmcnt(1)
    v_mfma_f32_32x32x16_bf16 v[128:143], a[0:3], v[200:203], 0
    v_max_f32 v246, v246, v3
    v_sub_f32 v246, v245, v246
    v_fma_f32 v72, v72, s29, v246
    v_fma_f32 v73, v73, s29, v246
    v_exp_f32 v72, v72
    v_mfma_f32_32x32x16_bf16 v[144:159], a[4:7], v[200:203], 0
    v_exp_f32 v73, v73
    v_fma_f32 v88, v88, s29, v246
    v_exp_f32 v88, v88
    v_fma_f32 v89, v89, s29, v246
    v_mfma_f32_32x32x16_bf16 v[160:175], a[8:11], v[200:203], 0
    ds_read_b128 v[200:203], v232 offset:28672
    v_exp_f32 v89, v89
    v_fma_f32 v74, v74, s29, v246
    v_add_f32 v2, v72, v73
    v_fma_f32 v75, v75, s29, v246
    v_mfma_f32_32x32x16_bf16 v[128:143], a[12:15], v[204:207], v[128:143]
    v_exp_f32 v74, v74
    v_add_f32 v2, v2, v88
    v_exp_f32 v75, v75
    v_fma_f32 v90, v90, s29, v246
    v_mfma_f32_32x32x16_bf16 v[144:159], a[16:19], v[204:207], v[144:159]
    v_add_f32 v2, v2, v89
    v_exp_f32 v90, v90
    v_fma_f32 v91, v91, s29, v246
    v_add_f32 v2, v2, v74
    v_fma_f32 v76, v76, s29, v246
    v_mfma_f32_32x32x16_bf16 v[160:175], a[20:23], v[204:207], v[160:175]
    ds_read_b128 v[204:207], v233 offset:28672
    v_exp_f32 v91, v91
    v_add_f32 v2, v2, v75
    v_exp_f32 v76, v76
    v_mfma_f32_32x32x16_bf16 v[128:143], a[24:27], v[208:211], v[128:143]
    v_fma_f32 v77, v77, s29, v246
    v_add_f32 v2, v2, v90
    v_exp_f32 v77, v77
    v_fma_f32 v92, v92, s29, v246
    v_add_f32 v2, v2, v91
    v_mfma_f32_32x32x16_bf16 v[144:159], a[28:31], v[208:211], v[144:159]
    v_exp_f32 v92, v92
    v_fma_f32 v93, v93, s29, v246
    v_add_f32 v2, v2, v76
    v_exp_f32 v93, v93
    v_mfma_f32_32x32x16_bf16 v[160:175], a[32:35], v[208:211], v[160:175]
    ds_read_b128 v[208:211], v234 offset:29696
    v_fma_f32 v78, v78, s29, v246
    v_add_f32 v2, v2, v77
    v_exp_f32 v78, v78
    v_fma_f32 v79, v79, s29, v246
    v_mfma_f32_32x32x16_bf16 v[128:143], a[36:39], v[212:215], v[128:143]
    v_add_f32 v2, v2, v92
    v_exp_f32 v79, v79
    v_fma_f32 v94, v94, s29, v246
    v_add_f32 v2, v2, v93
    v_fma_f32 v95, v95, s29, v246
    v_mfma_f32_32x32x16_bf16 v[144:159], a[40:43], v[212:215], v[144:159]
    v_exp_f32 v94, v94
    v_add_f32 v2, v2, v78
    v_exp_f32 v95, v95
    v_fma_f32 v80, v80, s29, v246
    v_mfma_f32_32x32x16_bf16 v[160:175], a[44:47], v[212:215], v[160:175]
    ds_read_b128 v[212:215], v235 offset:29696
    v_add_f32 v2, v2, v79
    v_exp_f32 v80, v80
    v_fma_f32 v81, v81, s29, v246
    v_add_f32 v2, v2, v94
    v_mfma_f32_32x32x16_bf16 v[128:143], a[48:51], v[216:219], v[128:143]
    v_exp_f32 v81, v81
    v_fma_f32 v96, v96, s29, v246
    v_add_f32 v2, v2, v95
    v_exp_f32 v96, v96
    v_mfma_f32_32x32x16_bf16 v[144:159], a[52:55], v[216:219], v[144:159]
    v_fma_f32 v97, v97, s29, v246
    v_add_f32 v2, v2, v80
    v_exp_f32 v97, v97
    v_fma_f32 v82, v82, s29, v246
    v_add_f32 v2, v2, v81
    v_mfma_f32_32x32x16_bf16 v[160:175], a[56:59], v[216:219], v[160:175]
    ds_read_b128 v[216:219], v232 offset:29696
    v_exp_f32 v82, v82
    v_fma_f32 v83, v83, s29, v246
    v_add_f32 v2, v2, v96
    s_waitcnt lgkmcnt(2)
    v_mfma_f32_32x32x16_bf16 v[128:143], a[60:63], v[220:223], v[128:143]
    v_exp_f32 v83, v83
    v_fma_f32 v98, v98, s29, v246
    v_add_f32 v2, v2, v97
    v_exp_f32 v98, v98
    v_mfma_f32_32x32x16_bf16 v[144:159], a[64:67], v[220:223], v[144:159]
    v_fma_f32 v99, v99, s29, v246
    v_cvt_pk_bf16_f32 v72, v72, v73
    v_cvt_pk_bf16_f32 v88, v88, v89
    v_add_f32 v2, v2, v82
    v_exp_f32 v99, v99
    v_mfma_f32_32x32x16_bf16 v[160:175], a[68:71], v[220:223], v[160:175]
    ds_read_b128 v[220:223], v233 offset:29696
    v_fma_f32 v84, v84, s29, v246
    v_cvt_pk_bf16_f32 v73, v74, v75
    v_cvt_pk_bf16_f32 v89, v90, v91
    v_add_f32 v2, v2, v83
    v_fma_f32 v85, v85, s29, v246
    v_mfma_f32_32x32x16_bf16 v[128:143], a[72:75], v[200:203], v[128:143]
    v_exp_f32 v84, v84
    v_cvt_pk_bf16_f32 v74, v76, v77
    v_cvt_pk_bf16_f32 v90, v92, v93
    v_cvt_pk_bf16_f32 v75, v78, v79
    v_cvt_pk_bf16_f32 v91, v94, v95
    v_mfma_f32_32x32x16_bf16 v[144:159], a[76:79], v[200:203], v[144:159]
    v_add_f32 v2, v2, v98
    v_exp_f32 v85, v85
    v_fma_f32 v100, v100, s29, v246
    v_permlane16_swap_b32 v72, v88
    v_permlane16_swap_b32 v73, v89
    v_mfma_f32_32x32x16_bf16 v[160:175], a[80:83], v[200:203], v[160:175]
    v_permlane16_swap_b32 v74, v90
    v_permlane16_swap_b32 v75, v91
    v_add_f32 v2, v2, v99
    v_exp_f32 v100, v100
    v_fma_f32 v101, v101, s29, v246
    v_mfma_f32_32x32x16_bf16 v[128:143], a[84:87], v[204:207], v[128:143]
    v_add_f32 v2, v2, v84
    v_exp_f32 v101, v101
    v_fma_f32 v86, v86, s29, v246
    v_cvt_pk_bf16_f32 v76, v80, v81
    v_cvt_pk_bf16_f32 v77, v82, v83
    v_mfma_f32_32x32x16_bf16 v[144:159], a[88:91], v[204:207], v[144:159]
    v_add_f32 v2, v2, v85
    v_exp_f32 v86, v86
    v_fma_f32 v87, v87, s29, v246
    v_add_f32 v2, v2, v100
    v_add_f32 v2, v2, v101
    v_mfma_f32_32x32x16_bf16 v[160:175], a[92:95], v[204:207], v[160:175]
    v_exp_f32 v87, v87
    v_add_f32 v2, v2, v86
    v_cvt_pk_bf16_f32 v78, v84, v85
    v_add_f32 v2, v2, v87
    v_cvt_pk_bf16_f32 v79, v86, v87
    v_mfma_f32_32x32x16_bf16 v[128:143], a[96:99], v[208:211], v[128:143]
    v_fma_f32 v102, v102, s29, v246
    v_cvt_pk_bf16_f32 v92, v96, v97
    v_cvt_pk_bf16_f32 v93, v98, v99
    v_exp_f32 v102, v102
    v_fma_f32 v103, v103, s29, v246
    v_mfma_f32_32x32x16_bf16 v[144:159], a[100:103], v[208:211], v[144:159]
    v_exp_f32 v103, v103
    v_add_f32 v2, v2, v102
    v_cvt_pk_bf16_f32 v94, v100, v101
    v_add_f32 v2, v2, v103
    v_cvt_pk_bf16_f32 v95, v102, v103
    v_mfma_f32_32x32x16_bf16 v[160:175], a[104:107], v[208:211], v[160:175]
    ds_read_b128 v[200:203], v236 offset:24576
    v_permlane16_swap_b32 v76, v92
    v_permlane16_swap_b32 v77, v93
    v_permlane16_swap_b32 v78, v94
    v_permlane16_swap_b32 v79, v95
    s_waitcnt lgkmcnt(1)
    v_mfma_f32_32x32x16_bf16 v[128:143], a[108:111], v[212:215], v[128:143]
    ds_read_b128 v[204:207], v237 offset:24576
    ds_read_b128 v[208:211], v236 offset:25600
    v_mov_b32 v3, v2
    v_permlane32_swap_b32 v0, v1
    v_add_f32 v0, v0, v1
    v_permlane32_swap_b32 v2, v3
    v_mfma_f32_32x32x16_bf16 v[144:159], a[112:115], v[212:215], v[144:159]
    v_add_f32 v2, v2, v3
    v_rcp_f32 v0, v0
    v_rcp_f32 v2, v2
    v_mov_b32 v1, v0
    v_mfma_f32_32x32x16_bf16 v[160:175], a[116:119], v[212:215], v[160:175]
    ds_read_b128 v[212:215], v237 offset:25600
    v_mov_b32 v3, v2
    v_permlane16_swap_b32 v0, v1
    v_mul_f32 v48, v48, v0
    v_permlane16_swap_b32 v2, v3
    v_mul_f32 v49, v49, v0
    v_mfma_f32_32x32x16_bf16 v[128:143], a[120:123], v[216:219], v[128:143]
    v_mul_f32 v64, v64, v1
    v_mul_f32 v65, v65, v1
    v_mul_f32 v50, v50, v0
    v_mul_f32 v51, v51, v0
    v_cvt_pk_bf16_f32 v48, v48, v49
    v_mul_f32 v224, v224, v0
    v_mfma_f32_32x32x16_bf16 v[144:159], a[124:127], v[216:219], v[144:159]
    v_mul_f32 v225, v225, v0
    v_mul_f32 v66, v66, v1
    v_mul_f32 v67, v67, v1
    v_cvt_pk_bf16_f32 v64, v64, v65
    v_mul_f32 v228, v228, v1
    v_mul_f32 v229, v229, v1
    v_mfma_f32_32x32x16_bf16 v[160:175], a[128:131], v[216:219], v[160:175]
    ds_read_b128 v[216:219], v236 offset:26624
    v_cvt_pk_bf16_f32 v49, v50, v51
    v_mul_f32 v52, v52, v0
    v_mul_f32 v53, v53, v0
    v_mul_f32 v54, v54, v0
    v_mul_f32 v55, v55, v0
    v_mfma_f32_32x32x16_bf16 v[128:143], a[132:135], v[220:223], v[128:143]
    v_mul_f32 v226, v226, v0
    v_mul_f32 v227, v227, v0
    v_cvt_pk_bf16_f32 v224, v224, v225
    v_cvt_pk_bf16_f32 v65, v66, v67
    v_mul_f32 v68, v68, v1
    v_mul_f32 v69, v69, v1
    v_mfma_f32_32x32x16_bf16 v[144:159], a[136:139], v[220:223], v[144:159]
    v_mul_f32 v70, v70, v1
    v_mul_f32 v71, v71, v1
    v_mul_f32 v230, v230, v1
    v_mul_f32 v231, v231, v1
    v_cvt_pk_bf16_f32 v228, v228, v229
    v_cvt_pk_bf16_f32 v128, v128, v129
    v_mfma_f32_32x32x16_bf16 v[160:175], a[140:143], v[220:223], v[160:175]
    v_cvt_pk_bf16_f32 v129, v130, v131
    v_cvt_pk_bf16_f32 v131, v134, v135
    v_cvt_pk_bf16_f32 v134, v140, v141
    v_cvt_pk_bf16_f32 v135, v142, v143
    v_cvt_pk_bf16_f32 v130, v132, v133
    v_cvt_pk_bf16_f32 v140, v152, v153
    v_mfma_f32_16x16x32_bf16 v[80:83], v[176:179], v[72:75], 0
    v_cvt_pk_bf16_f32 v141, v154, v155
    v_cvt_pk_bf16_f32 v142, v156, v157
    v_mfma_f32_16x16x32_bf16 v[84:87], v[180:183], v[72:75], 0
    v_cvt_pk_bf16_f32 v143, v158, v159
    v_cvt_pk_bf16_f32 v132, v136, v137
    v_mfma_f32_16x16x32_bf16 v[40:43], v[184:187], v[72:75], 0
    v_cvt_pk_bf16_f32 v136, v144, v145
    v_cvt_pk_bf16_f32 v144, v160, v161
    v_mfma_f32_16x16x32_bf16 v[96:99], v[176:179], v[88:91], 0
    v_cvt_pk_bf16_f32 v145, v162, v163
    ds_read_b128 v[220:223], v237 offset:26624
    v_mfma_f32_16x16x32_bf16 v[100:103], v[180:183], v[88:91], 0
    v_cvt_pk_bf16_f32 v137, v146, v147
    v_cvt_pk_bf16_f32 v146, v164, v165
    v_mfma_f32_16x16x32_bf16 v[44:47], v[184:187], v[88:91], 0
    v_cvt_pk_bf16_f32 v147, v166, v167
    v_cvt_pk_bf16_f32 v133, v138, v139
    v_mfma_f32_16x16x32_bf16 v[80:83], v[188:191], v[76:79], v[80:83]
    v_cvt_pk_bf16_f32 v138, v148, v149
    v_cvt_pk_bf16_f32 v148, v168, v169
    v_mfma_f32_16x16x32_bf16 v[84:87], v[192:195], v[76:79], v[84:87]
    v_cvt_pk_bf16_f32 v149, v170, v171
    v_cvt_pk_bf16_f32 v139, v150, v151
    v_mfma_f32_16x16x32_bf16 v[40:43], v[196:199], v[76:79], v[40:43]
    v_cvt_pk_bf16_f32 v150, v172, v173
    v_cvt_pk_bf16_f32 v151, v174, v175
    v_mfma_f32_16x16x32_bf16 v[96:99], v[188:191], v[92:95], v[96:99]
    v_mul_f32 v80, v80, v2
    v_mul_f32 v81, v81, v2
    v_mfma_f32_16x16x32_bf16 v[100:103], v[192:195], v[92:95], v[100:103]
    v_mul_f32 v82, v82, v2
    v_mul_f32 v83, v83, v2
    v_mfma_f32_16x16x32_bf16 v[44:47], v[196:199], v[92:95], v[44:47]
    v_cvt_pk_bf16_f32 v80, v80, v81
    s_waitcnt lgkmcnt(1)
    v_mfma_f32_16x16x32_bf16 v[152:155], v[200:203], a[144:147], 0
    v_mul_f32 v96, v96, v3
    v_mul_f32 v97, v97, v3
    v_mfma_f32_16x16x32_bf16 v[156:159], v[200:203], a[148:151], 0
    v_mul_f32 v40, v40, v2
    v_mul_f32 v41, v41, v2
    v_mfma_f32_16x16x32_bf16 v[160:163], v[200:203], a[152:155], 0
    ds_read_b128 v[200:203], v237 offset:30720
    v_mul_f32 v98, v98, v3
    v_mfma_f32_16x16x32_bf16 v[152:155], v[204:207], a[156:159], v[152:155]
    v_mul_f32 v99, v99, v3
    v_cvt_pk_bf16_f32 v96, v96, v97
    v_mfma_f32_16x16x32_bf16 v[156:159], v[204:207], a[160:163], v[156:159]
    v_mul_f32 v44, v44, v3
    v_mul_f32 v45, v45, v3
    v_mfma_f32_16x16x32_bf16 v[160:163], v[204:207], a[164:167], v[160:163]
    ds_read_b128 v[204:207], v236 offset:30720
    v_cvt_pk_bf16_f32 v81, v82, v83
    v_mfma_f32_16x16x32_bf16 v[152:155], v[208:211], a[168:171], v[152:155]
    v_mul_f32 v84, v84, v2
    v_mul_f32 v85, v85, v2
    v_mfma_f32_16x16x32_bf16 v[156:159], v[208:211], a[172:175], v[156:159]
    v_mul_f32 v86, v86, v2
    v_mul_f32 v87, v87, v2
    v_mfma_f32_16x16x32_bf16 v[160:163], v[208:211], a[176:179], v[160:163]
    ds_read_b128 v[208:211], v237 offset:31744
    v_mul_f32 v42, v42, v2
    v_mfma_f32_16x16x32_bf16 v[152:155], v[212:215], a[180:183], v[152:155]
    v_mul_f32 v43, v43, v2
    v_cvt_pk_bf16_f32 v40, v40, v41
    v_mfma_f32_16x16x32_bf16 v[156:159], v[212:215], a[184:187], v[156:159]
    v_cvt_pk_bf16_f32 v97, v98, v99
    v_mul_f32 v100, v100, v3
    v_mfma_f32_16x16x32_bf16 v[160:163], v[212:215], a[188:191], v[160:163]
    ds_read_b128 v[212:215], v236 offset:31744
    v_mul_f32 v101, v101, v3
    v_mfma_f32_16x16x32_bf16 v[152:155], v[216:219], a[192:195], v[152:155]
    v_mul_f32 v102, v102, v3
    v_mul_f32 v103, v103, v3
    v_mfma_f32_16x16x32_bf16 v[156:159], v[216:219], a[196:199], v[156:159]
    v_mul_f32 v46, v46, v3
    v_mul_f32 v47, v47, v3
    v_mfma_f32_16x16x32_bf16 v[160:163], v[216:219], a[200:203], v[160:163]
    ds_read_b128 v[216:219], v237 offset:32768
    s_waitcnt lgkmcnt(4)
    v_mfma_f32_16x16x32_bf16 v[152:155], v[220:223], a[204:207], v[152:155]
    v_cvt_pk_bf16_f32 v44, v44, v45
    v_cvt_pk_bf16_f32 v50, v52, v53
    v_mfma_f32_16x16x32_bf16 v[156:159], v[220:223], a[208:211], v[156:159]
    v_cvt_pk_bf16_f32 v51, v54, v55
    v_cvt_pk_bf16_f32 v225, v226, v227
    v_mfma_f32_16x16x32_bf16 v[160:163], v[220:223], a[212:215], v[160:163]
    ds_read_b128 v[220:223], v236 offset:32768
    v_cvt_pk_bf16_f32 v66, v68, v69
    v_mfma_f32_16x16x32_bf16 v[164:167], v[200:203], a[144:147], 0
    v_cvt_pk_bf16_f32 v176, v152, v153
    v_cvt_pk_bf16_f32 v177, v154, v155
    v_mfma_f32_16x16x32_bf16 v[168:171], v[200:203], a[148:151], 0
    v_cvt_pk_bf16_f32 v180, v156, v157
    v_cvt_pk_bf16_f32 v181, v158, v159
    v_mfma_f32_16x16x32_bf16 v[172:175], v[200:203], a[152:155], 0
    ds_read_b128 v[200:203], v236 offset:36864
    s_waitcnt lgkmcnt(4)
    v_mfma_f32_16x16x32_bf16 v[164:167], v[204:207], a[156:159], v[164:167]
    v_cvt_pk_bf16_f32 v184, v160, v161
    v_cvt_pk_bf16_f32 v185, v162, v163
    v_mfma_f32_16x16x32_bf16 v[168:171], v[204:207], a[160:163], v[168:171]
    v_cvt_pk_bf16_f32 v67, v70, v71
    v_cvt_pk_bf16_f32 v229, v230, v231
    v_mfma_f32_16x16x32_bf16 v[172:175], v[204:207], a[164:167], v[172:175]
    ds_read_b128 v[204:207], v237 offset:36864
    v_cvt_pk_bf16_f32 v82, v84, v85
    v_mfma_f32_16x16x32_bf16 v[164:167], v[208:211], a[168:171], v[164:167]
    v_cvt_pk_bf16_f32 v83, v86, v87
    v_cvt_pk_bf16_f32 v41, v42, v43
    v_mfma_f32_16x16x32_bf16 v[168:171], v[208:211], a[172:175], v[168:171]
    v_cvt_pk_bf16_f32 v98, v100, v101
    v_cvt_pk_bf16_f32 v99, v102, v103
    v_mfma_f32_16x16x32_bf16 v[172:175], v[208:211], a[176:179], v[172:175]
    ds_read_b128 v[208:211], v236 offset:37888
    s_waitcnt lgkmcnt(4)
    v_mfma_f32_16x16x32_bf16 v[164:167], v[212:215], a[180:183], v[164:167]
    v_cvt_pk_bf16_f32 v45, v46, v47
    ds_read_b128 v[56:59], v241 offset:32768
    v_mfma_f32_16x16x32_bf16 v[168:171], v[212:215], a[184:187], v[168:171]
    ds_write_b128 v239, v[48:51] offset:0
    v_mfma_f32_16x16x32_bf16 v[172:175], v[212:215], a[188:191], v[172:175]
    ds_read_b128 v[212:215], v237 offset:37888
    ds_read_b128 v[60:63], v241 offset:33792
    v_mfma_f32_16x16x32_bf16 v[164:167], v[216:219], a[192:195], v[164:167]
    ds_read_b128 v[68:71], v241 offset:35840
    ds_read_b128 v[72:75], v241 offset:36864
    v_mfma_f32_16x16x32_bf16 v[168:171], v[216:219], a[196:199], v[168:171]
    ds_write_b64 v240, v[224:225] offset:0
    v_mfma_f32_16x16x32_bf16 v[172:175], v[216:219], a[200:203], v[172:175]
    ds_read_b128 v[216:219], v236 offset:38912
    s_waitcnt lgkmcnt(10)
    v_mfma_f32_16x16x32_bf16 v[164:167], v[220:223], a[204:207], v[164:167]
    ds_read_b128 v[76:79], v241 offset:37888
    ds_read_b128 v[88:91], v241 offset:38912
    v_mfma_f32_16x16x32_bf16 v[168:171], v[220:223], a[208:211], v[168:171]
    ds_write_b128 v239, v[64:67] offset:6144
    v_mfma_f32_16x16x32_bf16 v[172:175], v[220:223], a[212:215], v[172:175]
    ds_read_b128 v[220:223], v237 offset:38912
    ds_read_b128 v[64:67], v241 offset:34816
    v_mfma_f32_16x16x32_bf16 v[152:155], v[200:203], a[144:147], 0
    v_cvt_pk_bf16_f32 v178, v164, v165
    v_cvt_pk_bf16_f32 v179, v166, v167
    v_mfma_f32_16x16x32_bf16 v[156:159], v[200:203], a[148:151], 0
    v_cvt_pk_bf16_f32 v182, v168, v169
    v_cvt_pk_bf16_f32 v183, v170, v171
    v_mfma_f32_16x16x32_bf16 v[160:163], v[200:203], a[152:155], 0
    ds_read_b128 v[200:203], v237 offset:43008
    s_waitcnt lgkmcnt(12)
    v_mfma_f32_16x16x32_bf16 v[152:155], v[204:207], a[156:159], v[152:155]
    v_cvt_pk_bf16_f32 v186, v172, v173
    v_cvt_pk_bf16_f32 v187, v174, v175
    v_mfma_f32_16x16x32_bf16 v[156:159], v[204:207], a[160:163], v[156:159]
    ds_write_b64 v240, v[228:229] offset:6144
    v_mfma_f32_16x16x32_bf16 v[160:163], v[204:207], a[164:167], v[160:163]
    ds_read_b128 v[204:207], v236 offset:43008
    ds_read_b128 v[92:95], v241 offset:39936
    v_mfma_f32_16x16x32_bf16 v[152:155], v[208:211], a[168:171], v[152:155]
    v_mad_i32_i24 v250, v253, s39, v250
    v_mad_i32_i24 v251, v254, s39, v251
    v_mfma_f32_16x16x32_bf16 v[156:159], v[208:211], a[172:175], v[156:159]
    ds_write_b128 v239, v[80:83] offset:12288
    v_mfma_f32_16x16x32_bf16 v[160:163], v[208:211], a[176:179], v[160:163]
    ds_read_b128 v[208:211], v237 offset:44032
    s_waitcnt lgkmcnt(8)
    v_mfma_f32_16x16x32_bf16 v[152:155], v[212:215], a[180:183], v[152:155]
    v_readlane_b32 s33, v244, 16
    v_mfma_f32_16x16x32_bf16 v[156:159], v[212:215], a[184:187], v[156:159]
    ds_write_b64 v240, v[40:41] offset:12288
    v_mfma_f32_16x16x32_bf16 v[160:163], v[212:215], a[188:191], v[160:163]
    ds_read_b128 v[212:215], v236 offset:44032
    v_mfma_f32_16x16x32_bf16 v[152:155], v[216:219], a[192:195], v[152:155]
    v_mfma_f32_16x16x32_bf16 v[156:159], v[216:219], a[196:199], v[156:159]
    ds_write_b128 v239, v[96:99] offset:18432
    v_mfma_f32_16x16x32_bf16 v[160:163], v[216:219], a[200:203], v[160:163]
    ds_read_b128 v[216:219], v237 offset:45056
    s_waitcnt lgkmcnt(8)
    v_mfma_f32_16x16x32_bf16 v[152:155], v[220:223], a[204:207], v[152:155]
    v_mfma_f32_16x16x32_bf16 v[156:159], v[220:223], a[208:211], v[156:159]
    ds_write_b64 v240, v[44:45] offset:18432
    v_mfma_f32_16x16x32_bf16 v[160:163], v[220:223], a[212:215], v[160:163]
    ds_read_b128 v[220:223], v236 offset:45056
    v_mfma_f32_16x16x32_bf16 v[164:167], v[200:203], a[144:147], 0
    v_mfma_f32_16x16x32_bf16 v[168:171], v[200:203], a[148:151], 0
    v_mfma_f32_16x16x32_bf16 v[172:175], v[200:203], a[152:155], 0
    s_waitcnt lgkmcnt(5)
    v_mfma_f32_16x16x32_bf16 v[164:167], v[204:207], a[156:159], v[164:167]
    v_cvt_pk_bf16_f32 v188, v152, v153
    v_cvt_pk_bf16_f32 v189, v154, v155
    v_mfma_f32_16x16x32_bf16 v[168:171], v[204:207], a[160:163], v[168:171]
    v_cvt_pk_bf16_f32 v192, v156, v157
    v_cvt_pk_bf16_f32 v193, v158, v159
    v_mfma_f32_16x16x32_bf16 v[172:175], v[204:207], a[164:167], v[172:175]
    v_cvt_pk_bf16_f32 v196, v160, v161
    v_cvt_pk_bf16_f32 v197, v162, v163
    v_mfma_f32_16x16x32_bf16 v[164:167], v[208:211], a[168:171], v[164:167]
    v_mfma_f32_16x16x32_bf16 v[168:171], v[208:211], a[172:175], v[168:171]
    s_waitcnt vmcnt(0) lgkmcnt(0)
    v_mfma_f32_16x16x32_bf16 v[172:175], v[208:211], a[176:179], v[172:175]
    s_barrier
    v_mfma_f32_16x16x32_bf16 v[164:167], v[212:215], a[180:183], v[164:167]
    ds_read_b128 v[200:203], v238 offset:0
    ds_read_b128 v[204:207], v238 offset:1024
    v_mfma_f32_16x16x32_bf16 v[168:171], v[212:215], a[184:187], v[168:171]
    ds_read_b128 v[208:211], v238 offset:4096
    v_mfma_f32_16x16x32_bf16 v[172:175], v[212:215], a[188:191], v[172:175]
    ds_read_b128 v[212:215], v238 offset:2048
    v_mfma_f32_16x16x32_bf16 v[164:167], v[216:219], a[192:195], v[164:167]
    v_mfma_f32_16x16x32_bf16 v[168:171], v[216:219], a[196:199], v[168:171]
    v_mfma_f32_16x16x32_bf16 v[172:175], v[216:219], a[200:203], v[172:175]
    ds_read_b128 v[216:219], v238 offset:3072
    v_mfma_f32_16x16x32_bf16 v[164:167], v[220:223], a[204:207], v[164:167]
    v_mfma_f32_16x16x32_bf16 v[168:171], v[220:223], a[208:211], v[168:171]
    v_mfma_f32_16x16x32_bf16 v[172:175], v[220:223], a[212:215], v[172:175]
    ds_read_b128 v[220:223], v238 offset:5120
    s_waitcnt lgkmcnt(5)
    v_mfma_f32_16x16x32_bf16 v[152:155], a[216:219], v[200:203], 0
    v_mfma_f32_16x16x32_bf16 v[156:159], a[220:223], v[200:203], 0
    v_mfma_f32_16x16x32_bf16 v[160:163], a[224:227], v[200:203], 0
    ds_read_b128 v[200:203], v238 offset:12288
    s_waitcnt lgkmcnt(4)
    v_mfma_f32_16x16x32_bf16 v[152:155], a[228:231], v[204:207], v[152:155]
    v_cvt_pk_bf16_f32 v190, v164, v165
    v_cvt_pk_bf16_f32 v191, v166, v167
    v_mfma_f32_16x16x32_bf16 v[156:159], a[232:235], v[204:207], v[156:159]
    v_cvt_pk_bf16_f32 v194, v168, v169
    v_cvt_pk_bf16_f32 v195, v170, v171
    v_mfma_f32_16x16x32_bf16 v[160:163], a[236:239], v[204:207], v[160:163]
    ds_read_b128 v[204:207], v238 offset:13312
    v_cvt_pk_bf16_f32 v198, v172, v173
    v_mfma_f32_16x16x32_bf16 v[152:155], a[240:243], v[208:211], v[152:155]
    v_cvt_pk_bf16_f32 v199, v174, v175
    v_mfma_f32_16x16x32_bf16 v[156:159], a[244:247], v[208:211], v[156:159]
    v_mfma_f32_16x16x32_bf16 v[160:163], a[248:251], v[208:211], v[160:163]
    ds_read_b128 v[208:211], v238 offset:16384
    s_waitcnt lgkmcnt(4)
    v_mfma_f32_16x16x32_bf16 v[152:155], a[252:255], v[212:215], v[152:155]
    v_mfma_f32_16x16x32_bf16 v[156:159], v[56:59], v[212:215], v[156:159]
    v_mfma_f32_16x16x32_bf16 v[160:163], v[60:63], v[212:215], v[160:163]
    ds_read_b128 v[212:215], v238 offset:14336
    v_mfma_f32_16x16x32_bf16 v[152:155], v[64:67], v[216:219], v[152:155]
    v_mfma_f32_16x16x32_bf16 v[156:159], v[68:71], v[216:219], v[156:159]
    v_mfma_f32_16x16x32_bf16 v[160:163], v[72:75], v[216:219], v[160:163]
    ds_read_b128 v[216:219], v238 offset:15360
    s_waitcnt lgkmcnt(4)
    v_mfma_f32_16x16x32_bf16 v[152:155], v[76:79], v[220:223], v[152:155]
    v_mfma_f32_16x16x32_bf16 v[156:159], v[88:91], v[220:223], v[156:159]
    v_mfma_f32_16x16x32_bf16 v[160:163], v[92:95], v[220:223], v[160:163]
    ds_read_b128 v[220:223], v238 offset:17408
    v_mfma_f32_16x16x32_bf16 v[164:167], a[216:219], v[200:203], 0
    v_mfma_f32_16x16x32_bf16 v[168:171], a[220:223], v[200:203], 0
    v_mfma_f32_16x16x32_bf16 v[172:175], a[224:227], v[200:203], 0
    ds_read_b128 v[200:203], v238 offset:6144
    s_waitcnt lgkmcnt(4)
    v_mfma_f32_16x16x32_bf16 v[164:167], a[228:231], v[204:207], v[164:167]
    v_cvt_pk_bf16_f32 v152, v152, v153
    v_cvt_pk_bf16_f32 v153, v154, v155
    v_mfma_f32_16x16x32_bf16 v[168:171], a[232:235], v[204:207], v[168:171]
    v_cvt_pk_bf16_f32 v154, v156, v157
    v_cvt_pk_bf16_f32 v155, v158, v159
    v_mfma_f32_16x16x32_bf16 v[172:175], a[236:239], v[204:207], v[172:175]
    ds_read_b128 v[204:207], v238 offset:7168
    v_cvt_pk_bf16_f32 v160, v160, v161
    v_mfma_f32_16x16x32_bf16 v[164:167], a[240:243], v[208:211], v[164:167]
    ds_write_b128 v247, v[152:155] offset:0
    v_mfma_f32_16x16x32_bf16 v[168:171], a[244:247], v[208:211], v[168:171]
    v_cvt_pk_bf16_f32 v161, v162, v163
    v_mfma_f32_16x16x32_bf16 v[172:175], a[248:251], v[208:211], v[172:175]
    ds_read_b128 v[208:211], v238 offset:10240
    s_waitcnt lgkmcnt(5)
    v_mfma_f32_16x16x32_bf16 v[164:167], a[252:255], v[212:215], v[164:167]
    ds_write_b64 v248, v[160:161] offset:0
    v_mfma_f32_16x16x32_bf16 v[168:171], v[56:59], v[212:215], v[168:171]
    v_mfma_f32_16x16x32_bf16 v[172:175], v[60:63], v[212:215], v[172:175]
    ds_read_b128 v[212:215], v238 offset:8192
    v_mfma_f32_16x16x32_bf16 v[164:167], v[64:67], v[216:219], v[164:167]
    v_mfma_f32_16x16x32_bf16 v[168:171], v[68:71], v[216:219], v[168:171]
    v_mfma_f32_16x16x32_bf16 v[172:175], v[72:75], v[216:219], v[172:175]
    ds_read_b128 v[216:219], v238 offset:9216
    s_waitcnt lgkmcnt(6)
    v_mfma_f32_16x16x32_bf16 v[164:167], v[76:79], v[220:223], v[164:167]
    v_mfma_f32_16x16x32_bf16 v[168:171], v[88:91], v[220:223], v[168:171]
    v_mfma_f32_16x16x32_bf16 v[172:175], v[92:95], v[220:223], v[172:175]
    ds_read_b128 v[220:223], v238 offset:11264
    v_mfma_f32_16x16x32_bf16 v[152:155], a[216:219], v[200:203], 0
    v_mfma_f32_16x16x32_bf16 v[156:159], a[220:223], v[200:203], 0
    v_mfma_f32_16x16x32_bf16 v[160:163], a[224:227], v[200:203], 0
    ds_read_b128 v[200:203], v238 offset:18432
    s_waitcnt lgkmcnt(4)
    v_mfma_f32_16x16x32_bf16 v[152:155], a[228:231], v[204:207], v[152:155]
    v_cvt_pk_bf16_f32 v164, v164, v165
    v_cvt_pk_bf16_f32 v165, v166, v167
    v_mfma_f32_16x16x32_bf16 v[156:159], a[232:235], v[204:207], v[156:159]
    v_cvt_pk_bf16_f32 v166, v168, v169
    v_cvt_pk_bf16_f32 v167, v170, v171
    v_mfma_f32_16x16x32_bf16 v[160:163], a[236:239], v[204:207], v[160:163]
    ds_read_b128 v[204:207], v238 offset:19456
    v_cvt_pk_bf16_f32 v172, v172, v173
    v_mfma_f32_16x16x32_bf16 v[152:155], a[240:243], v[208:211], v[152:155]
    ds_write_b128 v247, v[164:167] offset:768
    v_mfma_f32_16x16x32_bf16 v[156:159], a[244:247], v[208:211], v[156:159]
    v_cvt_pk_bf16_f32 v173, v174, v175
    v_mfma_f32_16x16x32_bf16 v[160:163], a[248:251], v[208:211], v[160:163]
    ds_read_b128 v[208:211], v238 offset:22528
    s_waitcnt lgkmcnt(5)
    v_mfma_f32_16x16x32_bf16 v[152:155], a[252:255], v[212:215], v[152:155]
    ds_write_b64 v248, v[172:173] offset:768
    v_mfma_f32_16x16x32_bf16 v[156:159], v[56:59], v[212:215], v[156:159]
    ds_read_b128 v[40:43], v241 offset:0
    ds_read_b128 v[44:47], v241 offset:1024
    v_mfma_f32_16x16x32_bf16 v[160:163], v[60:63], v[212:215], v[160:163]
    ds_read_b128 v[212:215], v238 offset:20480
    ds_read_b128 v[48:51], v241 offset:2048
    v_mfma_f32_16x16x32_bf16 v[152:155], v[64:67], v[216:219], v[152:155]
    v_mfma_f32_16x16x32_bf16 v[156:159], v[68:71], v[216:219], v[156:159]
    v_mfma_f32_16x16x32_bf16 v[160:163], v[72:75], v[216:219], v[160:163]
    ds_read_b128 v[216:219], v238 offset:21504
    s_waitcnt lgkmcnt(9)
    v_mfma_f32_16x16x32_bf16 v[152:155], v[76:79], v[220:223], v[152:155]
    v_mfma_f32_16x16x32_bf16 v[156:159], v[88:91], v[220:223], v[156:159]
    v_mfma_f32_16x16x32_bf16 v[160:163], v[92:95], v[220:223], v[160:163]
    ds_read_b128 v[220:223], v238 offset:23552
    v_mfma_f32_16x16x32_bf16 v[164:167], a[216:219], v[200:203], 0
    v_mfma_f32_16x16x32_bf16 v[168:171], a[220:223], v[200:203], 0
    v_mfma_f32_16x16x32_bf16 v[172:175], a[224:227], v[200:203], 0
    s_waitcnt lgkmcnt(5)
    v_mfma_f32_16x16x32_bf16 v[164:167], a[228:231], v[204:207], v[164:167]
    v_cvt_pk_bf16_f32 v152, v152, v153
    v_cvt_pk_bf16_f32 v153, v154, v155
    v_mfma_f32_16x16x32_bf16 v[168:171], a[232:235], v[204:207], v[168:171]
    v_cvt_pk_bf16_f32 v154, v156, v157
    v_cvt_pk_bf16_f32 v155, v158, v159
    v_mfma_f32_16x16x32_bf16 v[172:175], a[236:239], v[204:207], v[172:175]
    v_cvt_pk_bf16_f32 v160, v160, v161
    v_cvt_pk_bf16_f32 v161, v162, v163
    v_mfma_f32_16x16x32_bf16 v[164:167], a[240:243], v[208:211], v[164:167]
    ds_write_b128 v247, v[152:155] offset:3072
    v_mfma_f32_16x16x32_bf16 v[168:171], a[244:247], v[208:211], v[168:171]
    buffer_store_dwordx4 v[40:43], v249, s[12:15], s32 offen nt
    v_mfma_f32_16x16x32_bf16 v[172:175], a[248:251], v[208:211], v[172:175]
    s_waitcnt lgkmcnt(2)
    v_mfma_f32_16x16x32_bf16 v[164:167], a[252:255], v[212:215], v[164:167]
    ds_write_b64 v248, v[160:161] offset:3072
    v_mfma_f32_16x16x32_bf16 v[168:171], v[56:59], v[212:215], v[168:171]
    v_mfma_f32_16x16x32_bf16 v[172:175], v[60:63], v[212:215], v[172:175]
    v_mfma_f32_16x16x32_bf16 v[164:167], v[64:67], v[216:219], v[164:167]
    v_mfma_f32_16x16x32_bf16 v[168:171], v[68:71], v[216:219], v[168:171]
    buffer_store_dwordx4 v[44:47], v250, s[12:15], s32 offen nt
    v_mfma_f32_16x16x32_bf16 v[172:175], v[72:75], v[216:219], v[172:175]
    s_waitcnt lgkmcnt(2)
    v_mfma_f32_16x16x32_bf16 v[164:167], v[76:79], v[220:223], v[164:167]
    v_mfma_f32_16x16x32_bf16 v[168:171], v[88:91], v[220:223], v[168:171]
    v_mfma_f32_16x16x32_bf16 v[172:175], v[92:95], v[220:223], v[172:175]
    buffer_store_dwordx4 v[48:51], v251, s[12:15], s32 offen nt
    s_waitcnt lgkmcnt(0)
    s_branch LOOP
LAST:
    v_mfma_f32_32x32x16_bf16 v[40:55], v[116:119], v[104:107], v[4:19]
    v_cvt_pk_bf16_f32 v164, v164, v165
    v_cvt_pk_bf16_f32 v165, v166, v167
    v_cvt_pk_bf16_f32 v166, v168, v169
    v_cvt_pk_bf16_f32 v167, v170, v171
    v_cvt_pk_bf16_f32 v172, v172, v173
    v_cvt_pk_bf16_f32 v173, v174, v175
    v_mfma_f32_32x32x16_bf16 v[56:71], v[140:143], v[104:107], v[24:39]
    ds_write_b128 v247, v[164:167] offset:3840
    v_readlane_b32 s40, v244, 48
    v_readlane_b32 s39, v244, 32
    v_readlane_b32 s32, v244, 0
    v_mov_b32 v245, s40
    v_mfma_f32_32x32x16_bf16 v[40:55], v[120:123], v[108:111], v[40:55]
    v_cndmask_b32 v245, 0, v245, s[42:43]
    v_or_b32 v246, s41, v245
    ds_write_b64 v248, v[172:173] offset:3840
    ds_read_b128 v[152:155], v241 offset:3072
    ds_read_b128 v[156:159], v241 offset:4096
    v_mfma_f32_32x32x16_bf16 v[56:71], v[144:147], v[108:111], v[56:71]
    ds_read_b128 v[160:163], v241 offset:5120
    v_cndmask_b32 v232, v246, v245, s[44:45]
    v_cndmask_b32 v245, v245, v246, s[44:45]
    v_mfma_f32_32x32x16_bf16 v[40:55], v[124:127], v[112:115], v[40:55]
    v_mfma_f32_32x32x16_bf16 v[56:71], v[148:151], v[112:115], v[56:71]
    v_mfma_f32_32x32x16_bf16 v[72:87], v[116:119], v[128:131], v[20:35]
    v_mfma_f32_32x32x16_bf16 v[88:103], v[140:143], v[128:131], v[4:19]
    s_waitcnt lgkmcnt(2)
    buffer_store_dwordx4 v[152:155], v249, s[12:15], s33 offen nt
    v_mad_i32_i24 v249, v252, s39, v249
    v_mfma_f32_32x32x16_bf16 v[72:87], v[120:123], v[132:135], v[72:87]
    v_mfma_f32_32x32x16_bf16 v[88:103], v[144:147], v[132:135], v[88:103]
    v_mfma_f32_32x32x16_bf16 v[72:87], v[124:127], v[136:139], v[72:87]
    s_waitcnt lgkmcnt(0)
    buffer_store_dwordx4 v[156:159], v250, s[12:15], s33 offen nt
    v_mad_i32_i24 v250, v253, s39, v250
    v_max3_f32 v246, v40, v41, v42
    v_max3_f32 v233, v48, v49, v50
    v_max3_f32 v246, v246, v43, v44
    v_max3_f32 v233, v233, v51, v52
    v_max3_f32 v246, v246, v45, v46
    v_max3_f32 v233, v233, v53, v54
    v_max3_f32 v246, v246, v47, v56
    v_max3_f32 v233, v233, v55, v64
    v_max3_f32 v246, v246, v57, v58
    v_max3_f32 v233, v233, v65, v66
    v_max3_f32 v246, v246, v59, v60
    v_max3_f32 v233, v233, v67, v68
    v_max3_f32 v246, v246, v61, v62
    v_max3_f32 v233, v233, v69, v70
    v_max_f32 v246, v246, v63
    v_max_f32 v233, v233, v71
    v_fma_f32 v246, v246, s29, v245
    v_fma_f32 v233, v233, s29, v232
    v_max_f32 v246, v246, v233
    v_mov_b32 v1, v246
    buffer_store_dwordx4 v[160:163], v251, s[12:15], s33 offen nt
    v_mfma_f32_32x32x16_bf16 v[88:103], v[148:151], v[136:139], v[88:103]
    v_permlane32_swap_b32 v246, v1
    v_max_f32 v246, v246, v1
    v_sub_f32 v233, v232, v246
    v_sub_f32 v246, v245, v246
    v_pk_fma_f32 v[40:41], v[40:41], s[28:29], v[246:247] op_sel:[0,1,0] op_sel_hi:[1,1,0]
    v_pk_fma_f32 v[56:57], v[56:57], s[28:29], v[246:247] op_sel:[0,1,0] op_sel_hi:[1,1,0]
    v_pk_fma_f32 v[42:43], v[42:43], s[28:29], v[246:247] op_sel:[0,1,0] op_sel_hi:[1,1,0]
    v_pk_fma_f32 v[58:59], v[58:59], s[28:29], v[246:247] op_sel:[0,1,0] op_sel_hi:[1,1,0]
    v_pk_fma_f32 v[44:45], v[44:45], s[28:29], v[246:247] op_sel:[0,1,0] op_sel_hi:[1,1,0]
    v_pk_fma_f32 v[60:61], v[60:61], s[28:29], v[246:247] op_sel:[0,1,0] op_sel_hi:[1,1,0]
    v_pk_fma_f32 v[46:47], v[46:47], s[28:29], v[246:247] op_sel:[0,1,0] op_sel_hi:[1,1,0]
    v_pk_fma_f32 v[62:63], v[62:63], s[28:29], v[246:247] op_sel:[0,1,0] op_sel_hi:[1,1,0]
    v_pk_fma_f32 v[48:49], v[48:49], s[28:29], v[232:233] op_sel:[0,1,1] op_sel_hi:[1,1,1]
    v_pk_fma_f32 v[64:65], v[64:65], s[28:29], v[232:233] op_sel:[0,1,1] op_sel_hi:[1,1,1]
    v_pk_fma_f32 v[50:51], v[50:51], s[28:29], v[232:233] op_sel:[0,1,1] op_sel_hi:[1,1,1]
    v_pk_fma_f32 v[66:67], v[66:67], s[28:29], v[232:233] op_sel:[0,1,1] op_sel_hi:[1,1,1]
    v_pk_fma_f32 v[52:53], v[52:53], s[28:29], v[232:233] op_sel:[0,1,1] op_sel_hi:[1,1,1]
    v_pk_fma_f32 v[68:69], v[68:69], s[28:29], v[232:233] op_sel:[0,1,1] op_sel_hi:[1,1,1]
    v_pk_fma_f32 v[54:55], v[54:55], s[28:29], v[232:233] op_sel:[0,1,1] op_sel_hi:[1,1,1]
    v_pk_fma_f32 v[70:71], v[70:71], s[28:29], v[232:233] op_sel:[0,1,1] op_sel_hi:[1,1,1]
    v_max3_f32 v246, v72, v73, v74
    v_max3_f32 v233, v80, v81, v82
    v_exp_f32 v40, v40
    v_exp_f32 v41, v41
    v_max3_f32 v246, v246, v75, v76
    v_max3_f32 v233, v233, v83, v84
    v_exp_f32 v56, v56
    v_exp_f32 v57, v57
    v_max3_f32 v246, v246, v77, v78
    v_max3_f32 v233, v233, v85, v86
    v_exp_f32 v42, v42
    v_exp_f32 v43, v43
    v_max3_f32 v246, v246, v79, v88
    v_max3_f32 v233, v233, v87, v96
    v_mov_b32 v0, v40
    v_mov_b32 v1, v41
    v_exp_f32 v58, v58
    v_exp_f32 v59, v59
    v_max3_f32 v246, v246, v89, v90
    v_max3_f32 v233, v233, v97, v98
    v_pk_add_f32 v[0:1], v[0:1], v[56:57]
    v_exp_f32 v44, v44
    v_exp_f32 v45, v45
    v_max3_f32 v246, v246, v91, v92
    v_max3_f32 v233, v233, v99, v100
    v_pk_add_f32 v[0:1], v[0:1], v[42:43]
    v_exp_f32 v60, v60
    v_exp_f32 v61, v61
    v_max3_f32 v246, v246, v93, v94
    v_max3_f32 v233, v233, v101, v102
    v_pk_add_f32 v[0:1], v[0:1], v[58:59]
    v_exp_f32 v46, v46
    v_exp_f32 v47, v47
    v_max_f32 v246, v246, v95
    v_max_f32 v233, v233, v103
    v_pk_add_f32 v[0:1], v[0:1], v[44:45]
    v_exp_f32 v62, v62
    v_exp_f32 v63, v63
    v_fma_f32 v246, v246, s29, v245
    v_fma_f32 v233, v233, s29, v232
    v_cvt_pk_bf16_f32 v40, v40, v41
    v_cvt_pk_bf16_f32 v56, v56, v57
    v_pk_add_f32 v[0:1], v[0:1], v[60:61]
    v_exp_f32 v48, v48
    v_exp_f32 v49, v49
    v_max_f32 v246, v246, v233
    v_cvt_pk_bf16_f32 v41, v42, v43
    v_cvt_pk_bf16_f32 v57, v58, v59
    v_pk_add_f32 v[0:1], v[0:1], v[46:47]
    v_exp_f32 v64, v64
    v_exp_f32 v65, v65
    v_mov_b32 v3, v246
    v_cvt_pk_bf16_f32 v42, v44, v45
    v_cvt_pk_bf16_f32 v58, v60, v61
    v_cvt_pk_bf16_f32 v43, v46, v47
    v_pk_add_f32 v[0:1], v[0:1], v[62:63]
    v_cvt_pk_bf16_f32 v59, v62, v63
    v_exp_f32 v50, v50
    v_exp_f32 v51, v51
    v_permlane32_swap_b32 v246, v3
    v_permlane16_swap_b32 v40, v56
    v_permlane16_swap_b32 v41, v57
    v_permlane16_swap_b32 v42, v58
    v_permlane16_swap_b32 v43, v59
    v_pk_add_f32 v[0:1], v[0:1], v[48:49]
    v_exp_f32 v66, v66
    v_exp_f32 v67, v67
    v_max_f32 v246, v246, v3
    v_pk_add_f32 v[0:1], v[0:1], v[64:65]
    v_exp_f32 v52, v52
    v_exp_f32 v53, v53
    v_sub_f32 v233, v232, v246
    v_cvt_pk_bf16_f32 v44, v48, v49
    v_pk_add_f32 v[0:1], v[0:1], v[50:51]
    v_cvt_pk_bf16_f32 v45, v50, v51
    v_mfma_f32_16x16x32_bf16 v[48:51], v[176:179], v[40:43], 0
    v_exp_f32 v68, v68
    v_exp_f32 v69, v69
    v_sub_f32 v246, v245, v246
    v_pk_add_f32 v[0:1], v[0:1], v[66:67]
    v_exp_f32 v54, v54
    v_exp_f32 v55, v55
    v_pk_fma_f32 v[72:73], v[72:73], s[28:29], v[246:247] op_sel:[0,1,0] op_sel_hi:[1,1,0]
    v_pk_add_f32 v[0:1], v[0:1], v[52:53]
    v_exp_f32 v72, v72
    v_exp_f32 v73, v73
    v_pk_fma_f32 v[88:89], v[88:89], s[28:29], v[246:247] op_sel:[0,1,0] op_sel_hi:[1,1,0]
    v_pk_add_f32 v[0:1], v[0:1], v[68:69]
    v_exp_f32 v88, v88
    v_exp_f32 v89, v89
    v_pk_fma_f32 v[74:75], v[74:75], s[28:29], v[246:247] op_sel:[0,1,0] op_sel_hi:[1,1,0]
    v_cvt_pk_bf16_f32 v46, v52, v53
    v_pk_add_f32 v[0:1], v[0:1], v[54:55]
    v_cvt_pk_bf16_f32 v47, v54, v55
    v_mfma_f32_16x16x32_bf16 v[52:55], v[180:183], v[40:43], 0
    v_exp_f32 v74, v74
    v_exp_f32 v75, v75
    v_pk_fma_f32 v[90:91], v[90:91], s[28:29], v[246:247] op_sel:[0,1,0] op_sel_hi:[1,1,0]
    v_mfma_f32_16x16x32_bf16 v[224:227], v[184:187], v[40:43], 0
    v_mov_b32 v2, v72
    v_mov_b32 v3, v73
    v_exp_f32 v90, v90
    v_exp_f32 v91, v91
    v_pk_fma_f32 v[76:77], v[76:77], s[28:29], v[246:247] op_sel:[0,1,0] op_sel_hi:[1,1,0]
    v_pk_add_f32 v[2:3], v[2:3], v[88:89]
    v_exp_f32 v76, v76
    v_exp_f32 v77, v77
    v_pk_fma_f32 v[92:93], v[92:93], s[28:29], v[246:247] op_sel:[0,1,0] op_sel_hi:[1,1,0]
    v_pk_add_f32 v[2:3], v[2:3], v[74:75]
    v_exp_f32 v92, v92
    v_exp_f32 v93, v93
    v_pk_fma_f32 v[78:79], v[78:79], s[28:29], v[246:247] op_sel:[0,1,0] op_sel_hi:[1,1,0]
    v_pk_add_f32 v[2:3], v[2:3], v[90:91]
    v_exp_f32 v78, v78
    v_exp_f32 v79, v79
    v_pk_fma_f32 v[94:95], v[94:95], s[28:29], v[246:247] op_sel:[0,1,0] op_sel_hi:[1,1,0]
    v_pk_add_f32 v[2:3], v[2:3], v[76:77]
    v_exp_f32 v94, v94
    v_exp_f32 v95, v95
    v_pk_fma_f32 v[80:81], v[80:81], s[28:29], v[232:233] op_sel:[0,1,1] op_sel_hi:[1,1,1]
    v_pk_add_f32 v[2:3], v[2:3], v[92:93]
    v_exp_f32 v80, v80
    v_exp_f32 v81, v81
    v_pk_fma_f32 v[96:97], v[96:97], s[28:29], v[232:233] op_sel:[0,1,1] op_sel_hi:[1,1,1]
    v_pk_add_f32 v[2:3], v[2:3], v[78:79]
    v_exp_f32 v96, v96
    v_exp_f32 v97, v97
    v_pk_fma_f32 v[82:83], v[82:83], s[28:29], v[232:233] op_sel:[0,1,1] op_sel_hi:[1,1,1]
    v_cvt_pk_bf16_f32 v60, v64, v65
    v_cvt_pk_bf16_f32 v61, v66, v67
    v_mfma_f32_16x16x32_bf16 v[64:67], v[176:179], v[56:59], 0
    v_pk_add_f32 v[2:3], v[2:3], v[94:95]
    v_exp_f32 v82, v82
    v_exp_f32 v83, v83
    v_pk_fma_f32 v[98:99], v[98:99], s[28:29], v[232:233] op_sel:[0,1,1] op_sel_hi:[1,1,1]
    v_exp_f32 v70, v70
    v_exp_f32 v71, v71
    v_pk_add_f32 v[2:3], v[2:3], v[80:81]
    v_exp_f32 v98, v98
    v_exp_f32 v99, v99
    v_pk_fma_f32 v[84:85], v[84:85], s[28:29], v[232:233] op_sel:[0,1,1] op_sel_hi:[1,1,1]
    v_pk_add_f32 v[2:3], v[2:3], v[96:97]
    v_exp_f32 v84, v84
    v_exp_f32 v85, v85
    v_pk_fma_f32 v[100:101], v[100:101], s[28:29], v[232:233] op_sel:[0,1,1] op_sel_hi:[1,1,1]
    v_pk_add_f32 v[2:3], v[2:3], v[82:83]
    v_exp_f32 v100, v100
    v_exp_f32 v101, v101
    v_pk_fma_f32 v[86:87], v[86:87], s[28:29], v[232:233] op_sel:[0,1,1] op_sel_hi:[1,1,1]
    v_cvt_pk_bf16_f32 v62, v68, v69
    v_pk_add_f32 v[0:1], v[0:1], v[70:71]
    v_cvt_pk_bf16_f32 v63, v70, v71
    v_mfma_f32_16x16x32_bf16 v[68:71], v[180:183], v[56:59], 0
    v_pk_add_f32 v[2:3], v[2:3], v[98:99]
    v_exp_f32 v86, v86
    v_exp_f32 v87, v87
    v_pk_fma_f32 v[102:103], v[102:103], s[28:29], v[232:233] op_sel:[0,1,1] op_sel_hi:[1,1,1]
    v_mfma_f32_16x16x32_bf16 v[228:231], v[184:187], v[56:59], 0
    v_pk_add_f32 v[2:3], v[2:3], v[84:85]
    v_exp_f32 v102, v102
    v_exp_f32 v103, v103
    v_pk_add_f32 v[2:3], v[2:3], v[100:101]
    v_pk_add_f32 v[2:3], v[2:3], v[86:87]
    v_pk_add_f32 v[2:3], v[2:3], v[102:103]
    v_add_f32 v0, v0, v1
    v_add_f32 v2, v2, v3
    v_permlane16_swap_b32 v44, v60
    v_permlane16_swap_b32 v45, v61
    v_permlane16_swap_b32 v46, v62
    v_permlane16_swap_b32 v47, v63
    v_mov_b32 v1, v0
    v_mov_b32 v3, v2
    v_mfma_f32_16x16x32_bf16 v[48:51], v[188:191], v[44:47], v[48:51]
    v_permlane32_swap_b32 v0, v1
    v_permlane32_swap_b32 v2, v3
    v_add_f32 v0, v0, v1
    v_add_f32 v2, v2, v3
    v_mfma_f32_16x16x32_bf16 v[52:55], v[192:195], v[44:47], v[52:55]
    v_rcp_f32 v0, v0
    v_rcp_f32 v2, v2
    v_mov_b32 v1, v0
    v_mov_b32 v3, v2
    v_mfma_f32_16x16x32_bf16 v[224:227], v[196:199], v[44:47], v[224:227]
    v_permlane16_swap_b32 v0, v1
    v_permlane16_swap_b32 v2, v3
    v_mul_f32 v48, v48, v0
    v_mul_f32 v49, v49, v0
    v_mul_f32 v50, v50, v0
    v_mul_f32 v51, v51, v0
    v_cvt_pk_bf16_f32 v48, v48, v49
    v_cvt_pk_bf16_f32 v49, v50, v51
    v_mul_f32 v224, v224, v0
    v_mul_f32 v225, v225, v0
    v_mul_f32 v52, v52, v0
    v_mul_f32 v53, v53, v0
    v_mul_f32 v54, v54, v0
    v_mul_f32 v55, v55, v0
    v_mul_f32 v226, v226, v0
    v_mul_f32 v227, v227, v0
    v_cvt_pk_bf16_f32 v224, v224, v225
    v_mfma_f32_16x16x32_bf16 v[64:67], v[188:191], v[60:63], v[64:67]
    v_cvt_pk_bf16_f32 v50, v52, v53
    v_cvt_pk_bf16_f32 v51, v54, v55
    v_cvt_pk_bf16_f32 v225, v226, v227
    ds_write_b128 v239, v[48:51] offset:0
    v_mfma_f32_16x16x32_bf16 v[68:71], v[192:195], v[60:63], v[68:71]
    v_cvt_pk_bf16_f32 v72, v72, v73
    v_cvt_pk_bf16_f32 v88, v88, v89
    v_mfma_f32_16x16x32_bf16 v[228:231], v[196:199], v[60:63], v[228:231]
    v_mul_f32 v64, v64, v1
    v_mul_f32 v65, v65, v1
    v_mul_f32 v66, v66, v1
    v_mul_f32 v67, v67, v1
    v_cvt_pk_bf16_f32 v64, v64, v65
    v_cvt_pk_bf16_f32 v65, v66, v67
    v_mul_f32 v68, v68, v1
    v_mul_f32 v69, v69, v1
    v_mul_f32 v228, v228, v1
    v_mul_f32 v229, v229, v1
    v_mul_f32 v70, v70, v1
    v_mul_f32 v71, v71, v1
    v_mul_f32 v230, v230, v1
    v_mul_f32 v231, v231, v1
    v_cvt_pk_bf16_f32 v228, v228, v229
    v_cvt_pk_bf16_f32 v66, v68, v69
    v_cvt_pk_bf16_f32 v67, v70, v71
    v_cvt_pk_bf16_f32 v229, v230, v231
    ds_write_b64 v240, v[224:225] offset:0
    ds_write_b128 v239, v[64:67] offset:6144
    ds_write_b64 v240, v[228:229] offset:6144
    v_cvt_pk_bf16_f32 v73, v74, v75
    v_cvt_pk_bf16_f32 v89, v90, v91
    v_cvt_pk_bf16_f32 v74, v76, v77
    v_cvt_pk_bf16_f32 v90, v92, v93
    v_cvt_pk_bf16_f32 v75, v78, v79
    v_cvt_pk_bf16_f32 v91, v94, v95
    v_permlane16_swap_b32 v72, v88
    v_permlane16_swap_b32 v73, v89
    v_permlane16_swap_b32 v74, v90
    v_permlane16_swap_b32 v75, v91
    v_cvt_pk_bf16_f32 v76, v80, v81
    v_cvt_pk_bf16_f32 v77, v82, v83
    v_mfma_f32_16x16x32_bf16 v[80:83], v[176:179], v[72:75], 0
    v_cvt_pk_bf16_f32 v78, v84, v85
    v_cvt_pk_bf16_f32 v79, v86, v87
    v_mfma_f32_16x16x32_bf16 v[84:87], v[180:183], v[72:75], 0
    v_cvt_pk_bf16_f32 v92, v96, v97
    v_cvt_pk_bf16_f32 v93, v98, v99
    v_mfma_f32_16x16x32_bf16 v[40:43], v[184:187], v[72:75], 0
    v_cvt_pk_bf16_f32 v94, v100, v101
    v_cvt_pk_bf16_f32 v95, v102, v103
    v_mfma_f32_16x16x32_bf16 v[96:99], v[176:179], v[88:91], 0
    v_permlane16_swap_b32 v76, v92
    v_permlane16_swap_b32 v77, v93
    v_mfma_f32_16x16x32_bf16 v[100:103], v[180:183], v[88:91], 0
    v_permlane16_swap_b32 v78, v94
    v_permlane16_swap_b32 v79, v95
    v_mfma_f32_16x16x32_bf16 v[44:47], v[184:187], v[88:91], 0
    ds_read_b128 v[56:59], v241 offset:32768
    ds_read_b128 v[60:63], v241 offset:33792
    v_mfma_f32_16x16x32_bf16 v[80:83], v[188:191], v[76:79], v[80:83]
    ds_read_b128 v[64:67], v241 offset:34816
    ds_read_b128 v[68:71], v241 offset:35840
    v_mfma_f32_16x16x32_bf16 v[84:87], v[192:195], v[76:79], v[84:87]
    ds_read_b128 v[72:75], v241 offset:36864
    ds_read_b128 v[88:91], v241 offset:38912
    v_mfma_f32_16x16x32_bf16 v[40:43], v[196:199], v[76:79], v[40:43]
    ds_read_b128 v[76:79], v241 offset:37888
    v_readlane_b32 s33, v244, 16
    v_mul_f32 v80, v80, v2
    v_mul_f32 v81, v81, v2
    v_mul_f32 v82, v82, v2
    v_mul_f32 v83, v83, v2
    v_cvt_pk_bf16_f32 v80, v80, v81
    v_cvt_pk_bf16_f32 v81, v82, v83
    v_mul_f32 v40, v40, v2
    v_mul_f32 v41, v41, v2
    v_mul_f32 v84, v84, v2
    v_mul_f32 v85, v85, v2
    v_mul_f32 v86, v86, v2
    v_mul_f32 v87, v87, v2
    v_mul_f32 v42, v42, v2
    v_mul_f32 v43, v43, v2
    v_cvt_pk_bf16_f32 v40, v40, v41
    v_cvt_pk_bf16_f32 v82, v84, v85
    v_cvt_pk_bf16_f32 v83, v86, v87
    v_cvt_pk_bf16_f32 v41, v42, v43
    ds_write_b128 v239, v[80:83] offset:12288
    v_mfma_f32_16x16x32_bf16 v[96:99], v[188:191], v[92:95], v[96:99]
    v_mad_i32_i24 v251, v254, s39, v251
    v_mfma_f32_16x16x32_bf16 v[100:103], v[192:195], v[92:95], v[100:103]
    v_mfma_f32_16x16x32_bf16 v[44:47], v[196:199], v[92:95], v[44:47]
    ds_write_b64 v240, v[40:41] offset:12288
    ds_read_b128 v[92:95], v241 offset:39936
    s_nop 2
    v_mul_f32 v96, v96, v3
    v_mul_f32 v97, v97, v3
    v_mul_f32 v98, v98, v3
    v_mul_f32 v99, v99, v3
    v_cvt_pk_bf16_f32 v96, v96, v97
    v_mul_f32 v44, v44, v3
    v_mul_f32 v45, v45, v3
    v_cvt_pk_bf16_f32 v97, v98, v99
    v_mul_f32 v100, v100, v3
    v_mul_f32 v101, v101, v3
    v_mul_f32 v102, v102, v3
    v_mul_f32 v103, v103, v3
    v_mul_f32 v46, v46, v3
    v_mul_f32 v47, v47, v3
    v_cvt_pk_bf16_f32 v44, v44, v45
    v_cvt_pk_bf16_f32 v98, v100, v101
    v_cvt_pk_bf16_f32 v99, v102, v103
    v_cvt_pk_bf16_f32 v45, v46, v47
    ds_write_b128 v239, v[96:99] offset:18432
    ds_write_b64 v240, v[44:45] offset:18432
    s_waitcnt vmcnt(0) lgkmcnt(0)
    s_barrier
    ds_read_b128 v[200:203], v238 offset:0
    ds_read_b128 v[204:207], v238 offset:1024
    ds_read_b128 v[208:211], v238 offset:4096
    ds_read_b128 v[212:215], v238 offset:2048
    ds_read_b128 v[216:219], v238 offset:3072
    ds_read_b128 v[220:223], v238 offset:5120
    s_waitcnt lgkmcnt(5)
    v_mfma_f32_16x16x32_bf16 v[152:155], a[216:219], v[200:203], 0
    v_mfma_f32_16x16x32_bf16 v[156:159], a[220:223], v[200:203], 0
    v_mfma_f32_16x16x32_bf16 v[160:163], a[224:227], v[200:203], 0
    ds_read_b128 v[200:203], v238 offset:12288
    s_waitcnt lgkmcnt(5)
    v_mfma_f32_16x16x32_bf16 v[152:155], a[228:231], v[204:207], v[152:155]
    v_mfma_f32_16x16x32_bf16 v[156:159], a[232:235], v[204:207], v[156:159]
    v_mfma_f32_16x16x32_bf16 v[160:163], a[236:239], v[204:207], v[160:163]
    ds_read_b128 v[204:207], v238 offset:13312
    s_waitcnt lgkmcnt(2)
    v_mfma_f32_16x16x32_bf16 v[152:155], a[240:243], v[208:211], v[152:155]
    v_mfma_f32_16x16x32_bf16 v[156:159], a[244:247], v[208:211], v[156:159]
    v_mfma_f32_16x16x32_bf16 v[160:163], a[248:251], v[208:211], v[160:163]
    ds_read_b128 v[208:211], v238 offset:16384
    v_mfma_f32_16x16x32_bf16 v[152:155], a[252:255], v[212:215], v[152:155]
    v_mfma_f32_16x16x32_bf16 v[156:159], v[56:59], v[212:215], v[156:159]
    v_mfma_f32_16x16x32_bf16 v[160:163], v[60:63], v[212:215], v[160:163]
    ds_read_b128 v[212:215], v238 offset:14336
    v_mfma_f32_16x16x32_bf16 v[152:155], v[64:67], v[216:219], v[152:155]
    v_mfma_f32_16x16x32_bf16 v[156:159], v[68:71], v[216:219], v[156:159]
    v_mfma_f32_16x16x32_bf16 v[160:163], v[72:75], v[216:219], v[160:163]
    ds_read_b128 v[216:219], v238 offset:15360
    v_mfma_f32_16x16x32_bf16 v[152:155], v[76:79], v[220:223], v[152:155]
    v_mfma_f32_16x16x32_bf16 v[156:159], v[88:91], v[220:223], v[156:159]
    v_mfma_f32_16x16x32_bf16 v[160:163], v[92:95], v[220:223], v[160:163]
    ds_read_b128 v[220:223], v238 offset:17408
    s_waitcnt lgkmcnt(4)
    v_mfma_f32_16x16x32_bf16 v[164:167], a[216:219], v[200:203], 0
    v_mfma_f32_16x16x32_bf16 v[168:171], a[220:223], v[200:203], 0
    v_mfma_f32_16x16x32_bf16 v[172:175], a[224:227], v[200:203], 0
    ds_read_b128 v[200:203], v238 offset:6144
    v_cvt_pk_bf16_f32 v152, v152, v153
    v_mfma_f32_16x16x32_bf16 v[164:167], a[228:231], v[204:207], v[164:167]
    v_cvt_pk_bf16_f32 v153, v154, v155
    v_cvt_pk_bf16_f32 v154, v156, v157
    v_mfma_f32_16x16x32_bf16 v[168:171], a[232:235], v[204:207], v[168:171]
    v_cvt_pk_bf16_f32 v155, v158, v159
    v_cvt_pk_bf16_f32 v160, v160, v161
    v_mfma_f32_16x16x32_bf16 v[172:175], a[236:239], v[204:207], v[172:175]
    ds_read_b128 v[204:207], v238 offset:7168
    s_waitcnt lgkmcnt(4)
    v_mfma_f32_16x16x32_bf16 v[164:167], a[240:243], v[208:211], v[164:167]
    ds_write_b128 v247, v[152:155] offset:0
    v_mfma_f32_16x16x32_bf16 v[168:171], a[244:247], v[208:211], v[168:171]
    v_cvt_pk_bf16_f32 v161, v162, v163
    v_mfma_f32_16x16x32_bf16 v[172:175], a[248:251], v[208:211], v[172:175]
    ds_read_b128 v[208:211], v238 offset:10240
    v_mfma_f32_16x16x32_bf16 v[164:167], a[252:255], v[212:215], v[164:167]
    ds_write_b64 v248, v[160:161] offset:0
    v_mfma_f32_16x16x32_bf16 v[168:171], v[56:59], v[212:215], v[168:171]
    v_mfma_f32_16x16x32_bf16 v[172:175], v[60:63], v[212:215], v[172:175]
    ds_read_b128 v[212:215], v238 offset:8192
    s_waitcnt lgkmcnt(6)
    v_mfma_f32_16x16x32_bf16 v[164:167], v[64:67], v[216:219], v[164:167]
    v_mfma_f32_16x16x32_bf16 v[168:171], v[68:71], v[216:219], v[168:171]
    v_mfma_f32_16x16x32_bf16 v[172:175], v[72:75], v[216:219], v[172:175]
    ds_read_b128 v[216:219], v238 offset:9216
    v_mfma_f32_16x16x32_bf16 v[164:167], v[76:79], v[220:223], v[164:167]
    v_mfma_f32_16x16x32_bf16 v[168:171], v[88:91], v[220:223], v[168:171]
    v_mfma_f32_16x16x32_bf16 v[172:175], v[92:95], v[220:223], v[172:175]
    ds_read_b128 v[220:223], v238 offset:11264
    s_waitcnt lgkmcnt(5)
    v_mfma_f32_16x16x32_bf16 v[152:155], a[216:219], v[200:203], 0
    v_mfma_f32_16x16x32_bf16 v[156:159], a[220:223], v[200:203], 0
    v_mfma_f32_16x16x32_bf16 v[160:163], a[224:227], v[200:203], 0
    ds_read_b128 v[200:203], v238 offset:18432
    v_cvt_pk_bf16_f32 v164, v164, v165
    v_mfma_f32_16x16x32_bf16 v[152:155], a[228:231], v[204:207], v[152:155]
    v_cvt_pk_bf16_f32 v165, v166, v167
    v_cvt_pk_bf16_f32 v166, v168, v169
    v_mfma_f32_16x16x32_bf16 v[156:159], a[232:235], v[204:207], v[156:159]
    v_cvt_pk_bf16_f32 v167, v170, v171
    v_cvt_pk_bf16_f32 v172, v172, v173
    v_mfma_f32_16x16x32_bf16 v[160:163], a[236:239], v[204:207], v[160:163]
    ds_read_b128 v[204:207], v238 offset:19456
    s_waitcnt lgkmcnt(4)
    v_mfma_f32_16x16x32_bf16 v[152:155], a[240:243], v[208:211], v[152:155]
    ds_write_b128 v247, v[164:167] offset:768
    v_mfma_f32_16x16x32_bf16 v[156:159], a[244:247], v[208:211], v[156:159]
    v_cvt_pk_bf16_f32 v173, v174, v175
    v_mfma_f32_16x16x32_bf16 v[160:163], a[248:251], v[208:211], v[160:163]
    ds_read_b128 v[208:211], v238 offset:22528
    v_mfma_f32_16x16x32_bf16 v[152:155], a[252:255], v[212:215], v[152:155]
    ds_write_b64 v248, v[172:173] offset:768
    v_mfma_f32_16x16x32_bf16 v[156:159], v[56:59], v[212:215], v[156:159]
    ds_read_b128 v[40:43], v241 offset:0
    ds_read_b128 v[44:47], v241 offset:1024
    v_mfma_f32_16x16x32_bf16 v[160:163], v[60:63], v[212:215], v[160:163]
    ds_read_b128 v[212:215], v238 offset:20480
    s_waitcnt lgkmcnt(8)
    v_mfma_f32_16x16x32_bf16 v[152:155], v[64:67], v[216:219], v[152:155]
    ds_read_b128 v[48:51], v241 offset:2048
    v_mfma_f32_16x16x32_bf16 v[156:159], v[68:71], v[216:219], v[156:159]
    v_mfma_f32_16x16x32_bf16 v[160:163], v[72:75], v[216:219], v[160:163]
    ds_read_b128 v[216:219], v238 offset:21504
    v_mfma_f32_16x16x32_bf16 v[152:155], v[76:79], v[220:223], v[152:155]
    v_mfma_f32_16x16x32_bf16 v[156:159], v[88:91], v[220:223], v[156:159]
    v_mfma_f32_16x16x32_bf16 v[160:163], v[92:95], v[220:223], v[160:163]
    ds_read_b128 v[220:223], v238 offset:23552
    s_waitcnt lgkmcnt(8)
    v_mfma_f32_16x16x32_bf16 v[164:167], a[216:219], v[200:203], 0
    v_mfma_f32_16x16x32_bf16 v[168:171], a[220:223], v[200:203], 0
    v_mfma_f32_16x16x32_bf16 v[172:175], a[224:227], v[200:203], 0
    v_mfma_f32_16x16x32_bf16 v[164:167], a[228:231], v[204:207], v[164:167]
    v_cvt_pk_bf16_f32 v152, v152, v153
    v_cvt_pk_bf16_f32 v153, v154, v155
    v_mfma_f32_16x16x32_bf16 v[168:171], a[232:235], v[204:207], v[168:171]
    v_cvt_pk_bf16_f32 v154, v156, v157
    v_cvt_pk_bf16_f32 v155, v158, v159
    v_mfma_f32_16x16x32_bf16 v[172:175], a[236:239], v[204:207], v[172:175]
    v_cvt_pk_bf16_f32 v160, v160, v161
    s_waitcnt lgkmcnt(2)
    v_mfma_f32_16x16x32_bf16 v[164:167], a[240:243], v[208:211], v[164:167]
    ds_write_b128 v247, v[152:155] offset:3072
    v_mfma_f32_16x16x32_bf16 v[168:171], a[244:247], v[208:211], v[168:171]
    v_cvt_pk_bf16_f32 v161, v162, v163
    v_mfma_f32_16x16x32_bf16 v[172:175], a[248:251], v[208:211], v[172:175]
    buffer_store_dwordx4 v[40:43], v249, s[12:15], s32 offen nt
    v_mfma_f32_16x16x32_bf16 v[164:167], a[252:255], v[212:215], v[164:167]
    ds_write_b64 v248, v[160:161] offset:3072
    v_mfma_f32_16x16x32_bf16 v[168:171], v[56:59], v[212:215], v[168:171]
    v_mfma_f32_16x16x32_bf16 v[172:175], v[60:63], v[212:215], v[172:175]
    s_waitcnt lgkmcnt(2)
    v_mfma_f32_16x16x32_bf16 v[164:167], v[64:67], v[216:219], v[164:167]
    v_mfma_f32_16x16x32_bf16 v[168:171], v[68:71], v[216:219], v[168:171]
    v_mfma_f32_16x16x32_bf16 v[172:175], v[72:75], v[216:219], v[172:175]
    buffer_store_dwordx4 v[44:47], v250, s[12:15], s32 offen nt
    v_mfma_f32_16x16x32_bf16 v[164:167], v[76:79], v[220:223], v[164:167]
    v_mfma_f32_16x16x32_bf16 v[168:171], v[88:91], v[220:223], v[168:171]
    v_mfma_f32_16x16x32_bf16 v[172:175], v[92:95], v[220:223], v[172:175]
    buffer_store_dwordx4 v[48:51], v251, s[12:15], s32 offen nt
    s_nop 4
    v_cvt_pk_bf16_f32 v164, v164, v165
    v_cvt_pk_bf16_f32 v165, v166, v167
    v_cvt_pk_bf16_f32 v166, v168, v169
    v_cvt_pk_bf16_f32 v167, v170, v171
    v_cvt_pk_bf16_f32 v172, v172, v173
    ds_write_b128 v247, v[164:167] offset:3840
    v_cvt_pk_bf16_f32 v173, v174, v175
    ds_write_b64 v248, v[172:173] offset:3840
    ds_read_b128 v[152:155], v241 offset:3072
    ds_read_b128 v[156:159], v241 offset:4096
    ds_read_b128 v[160:163], v241 offset:5120
    s_waitcnt lgkmcnt(2)
    buffer_store_dwordx4 v[152:155], v249, s[12:15], s33 offen nt
    s_waitcnt lgkmcnt(1)
    buffer_store_dwordx4 v[156:159], v250, s[12:15], s33 offen nt
    s_waitcnt lgkmcnt(0)
    buffer_store_dwordx4 v[160:163], v251, s[12:15], s33 offen nt
    s_waitcnt lgkmcnt(0)
    s_waitcnt vmcnt(0)
DONE:
    s_endpgm
.section .rodata,"a"
.p2align 6
.amdhsa_kernel standalone__window_attn_swin__vision_kernel
  .amdhsa_next_free_vgpr 512
  .amdhsa_next_free_sgpr 102
  .amdhsa_accum_offset 256
  .amdhsa_group_segment_fixed_size 0
  .amdhsa_kernarg_size 72
  .amdhsa_user_sgpr_count 2
  .amdhsa_user_sgpr_kernarg_segment_ptr 1
  .amdhsa_system_sgpr_workgroup_id_x 1
.end_amdhsa_kernel
```
